```python
import torch

def _softmax(x, axis=-1):
    return torch.softmax(x, dim=axis)
def _gelu(x):
    return torch.nn.functional.gelu(x, approximate="tanh")
def _silu(x):
    return torch.nn.functional.silu(x)
def _sigmoid(x):
    return torch.sigmoid(x)
def _layernorm(x, axis=-1, eps=1e-5):
    m = x.mean(dim=axis, keepdim=True)
    v = x.var(dim=axis, keepdim=True, unbiased=False)
    return (x - m) / torch.sqrt(v + eps)
def _scatter_add(tgt, idx, src, axis=0):
    return tgt.clone().index_add_(axis, idx, src)
def _segment_sum(src, seg, n):
    out = torch.zeros((n,) + src.shape[1:], dtype=src.dtype)
    return out.index_add_(0, seg, src)
def _pad(x, pw):
    flat = tuple(v for pair in reversed(pw) for v in pair)
    return torch.nn.functional.pad(x, flat)

kernel_name = 'gated_mix__ssm_conv_s5__dense_activation_relu__prompt'

def setup_inputs():

    _w = (lambda a: (lambda t: t.to(torch.bfloat16) if t.is_floating_point() else t)(torch.as_tensor(a)))
    def _A_setup():
        B, S, D = 1, 2048, 640
        P = D
        Lambda_re = -0.5 * (lambda _x: torch.exp(torch.as_tensor(_x)))((lambda *s: torch.randn(*s, dtype=torch.bfloat16) * 0.8)(P))
        Lambda_im = (lambda *s: torch.randn(*s, dtype=torch.bfloat16) * 0.8)(P) * 1.0
        B_re = (lambda *s: torch.randn(*s, dtype=torch.bfloat16) * 0.8)(P, D) * (D ** -0.5)
        B_im = (lambda *s: torch.randn(*s, dtype=torch.bfloat16) * 0.8)(P, D) * (D ** -0.5)
        C_re = (lambda *s: torch.randn(*s, dtype=torch.bfloat16) * 0.8)(D, P) * (P ** -0.5)
        C_im = (lambda *s: torch.randn(*s, dtype=torch.bfloat16) * 0.8)(D, P) * (P ** -0.5)
        log_dt = (lambda *s: torch.randn(*s, dtype=torch.bfloat16) * 0.8)(P) * 0.3 - 2.0
        Dskip = (lambda *s: torch.randn(*s, dtype=torch.bfloat16) * 0.8)(D)
        return {
            "x": _w((lambda *s: torch.randn(*s, dtype=torch.bfloat16) * 0.05)(B, S, D)),
            "Lambda_re": _w(Lambda_re),
            "Lambda_im": _w(Lambda_im),
            "B_re": _w(B_re),
            "B_im": _w(B_im),
            "C_re": _w(C_re),
            "C_im": _w(C_im),
            "log_dt": _w(log_dt),
            "Dskip": _w(Dskip),
        }
    _A_in = _A_setup()

    def _B_setup():
        B, S, D, Dff = 1, 2048, 640, 1536
        return {
            "x": _w((lambda *s: torch.randn(*s, dtype=torch.bfloat16) * 0.05)(B, S, D)),
            "w1": _w((lambda *s: torch.randn(*s, dtype=torch.bfloat16) * 0.05)(D, Dff)),
            "w2": _w((lambda *s: torch.randn(*s, dtype=torch.bfloat16) * 0.05)(Dff, D)),
        }
    _B_in = _B_setup()

    return {
        "A_x": _A_in["x"],
        "A_Lambda_re": _A_in["Lambda_re"],
        "A_Lambda_im": _A_in["Lambda_im"],
        "A_B_re": _A_in["B_re"],
        "A_B_im": _A_in["B_im"],
        "A_C_re": _A_in["C_re"],
        "A_C_im": _A_in["C_im"],
        "A_log_dt": _A_in["log_dt"],
        "A_Dskip": _A_in["Dskip"],
        "B_x": _B_in["x"],
        "B_w1": _B_in["w1"],
        "B_w2": _B_in["w2"],
        "gate_w": _w((lambda *s: torch.randn(*s, dtype=torch.bfloat16) * 0.05)(640) * 16.0),
    }

def reference(A_x, A_Lambda_re, A_Lambda_im, A_B_re, A_B_im, A_C_re, A_C_im, A_log_dt, A_Dskip, B_x, B_w1, B_w2, gate_w):
    def _A_ref(x, Lambda_re, Lambda_im, B_re, B_im, C_re, C_im, log_dt, Dskip):
        Bsz, L, H = x.shape
        Lam = Lambda_re + 1j * Lambda_im
        Bmat = B_re + 1j * B_im
        Cmat = C_re + 1j * C_im
        dt = torch.exp(log_dt)
        Lam_bar = torch.exp(dt * Lam)
        B_bar = ((Lam_bar - 1.0) / Lam)[:, None] * Bmat
        Bu = torch.einsum("bld,pd->blp", x + 0j, B_bar)
        h = torch.zeros_like(Bu[:, 0, :])
        hs = []
        for t in range(L):
            h = Lam_bar[None, :] * h + Bu[:, t, :]
            hs.append(h)
        hseq = torch.stack(hs, 1)
        y = 2.0 * torch.einsum("blp,dp->bld", hseq, Cmat).real + x * Dskip[None, None, :]
        return y

    def _B_ref(x, w1, w2):
        h = torch.einsum("bsd,df->bsf", x, w1)
        zero = torch.zeros_like(h)
        h = torch.maximum(h, zero)
        return torch.einsum("bsf,fd->bsd", h, w2)

    x = A_x
    g = _sigmoid((x * gate_w).sum(-1, keepdims=True))
    a = _A_ref(x, A_Lambda_re, A_Lambda_im, A_B_re, A_B_im, A_C_re, A_C_im, A_log_dt, A_Dskip)
    b = _B_ref(x, B_w1, B_w2)
    return g * a + (1 - g) * b
```

```asm
; @launch grid=(256,1,1) block=(256,1,1) lds=163840
.amdgcn_target "amdgcn-amd-amdhsa--gfx950"
.text
.globl gated_mix__ssm_conv_s5__dense_activation_relu__prompt_kernel
.p2align 8
.type gated_mix__ssm_conv_s5__dense_activation_relu__prompt_kernel,@function
gated_mix__ssm_conv_s5__dense_activation_relu__prompt_kernel:
    s_cmp_ge_u32 s2, 256
    s_cbranch_scc1 L_exit
    s_load_dwordx16 s[4:19], s[0:1], 0
    s_load_dwordx16 s[20:35], s[0:1], 64
    v_and_b32 v1, 63, v0
    v_lshrrev_b32 v2, 6, v0
    s_nop 0
    v_readfirstlane_b32 s38, v2
    s_and_b32 s41, s2, 3
    s_lshl_b32 s41, s41, 2
    s_bfe_u32 s42, s2, 0x20003
    s_add_u32 s36, s41, s42
    s_lshr_b32 s42, s2, 5
    s_bfe_u32 s43, s2, 0x10002
    s_bfe_u32 s44, s2, 0x20003
    s_mul_i32 s44, s44, 5
    s_add_u32 s44, s44, 1
    s_lshr_b32 s44, s44, 1
    s_add_u32 s44, s44, s42
    s_cmp_ge_u32 s44, 10
    s_cselect_b32 s45, 10, 0
    s_sub_u32 s44, s44, s45
    s_lshl_b32 s68, s44, 7
    s_cmp_ge_u32 s42, 5
    s_cbranch_scc1 L_ffn
    s_mul_i32 s43, s43, 5
    s_add_u32 s37, s43, s42
    s_lshr_b32 s39, s38, 1
    s_and_b32 s40, s38, 1
    v_lshrrev_b32 v2, 4, v1
    v_and_b32 v3, 7, v1
    v_xor_b32 v3, v2, v3
    v_lshlrev_b32 v3, 4, v3
    v_xor_b32 v4, 64, v3
    v_lshrrev_b32 v5, 5, v1
    v_lshlrev_b32 v5, 5, v5
    v_bfe_u32 v6, v1, 3, 1
    v_lshl_add_u32 v5, v6, 4, v5
    v_bfe_u32 v6, v1, 4, 1
    v_add_u32 v5, v5, v6
    s_lshl_b32 s41, s36, 7
    s_lshl_b32 s42, s39, 6
    s_add_u32 s41, s41, s42
    s_lshl_b32 s42, s40, 3
    s_add_u32 s41, s41, s42
    v_add_u32 v5, s41, v5
    v_mul_u32_u24 v5, 1280, v5
    v_add_u32 v10, v5, v3
    v_add_u32 v11, v5, v4
    v_add_u32 v11, 1536, v11
    v_add_u32 v12, v5, v3
    v_add_u32 v12, 3072, v12
    v_add_u32 v13, v5, v4
    v_add_u32 v13, 4608, v13
    s_lshl_b32 s41, s37, 6
    s_lshl_b32 s42, s39, 5
    s_add_u32 s41, s41, s42
    v_lshrrev_b32 v5, 3, v1
    v_add_u32 v5, s41, v5
    v_mul_u32_u24 v5, 1280, v5
    v_add_u32 v14, v5, v3
    v_add_u32 v15, v5, v4
    v_add_u32 v15, 9216, v15
    v_add_u32 v16, v5, v3
    v_add_u32 v16, 18432, v16
    v_add_u32 v17, v5, v4
    v_add_u32 v17, 27648, v17
    s_lshl_b32 s69, s38, 12
    s_add_u32 s70, s69, 16384
    s_lshl_b32 s41, s37, 6
    s_lshl_b32 s42, s40, 5
    s_add_u32 s41, s41, s42
    v_and_b32 v60, 31, v1
    v_add_u32 v60, s41, v60
    v_lshlrev_b32 v60, 1, v60
    v_lshlrev_b32 v248, 4, v1
    v_add_u32 v249, 4096, v248
    s_waitcnt lgkmcnt(0)
    s_mov_b32 s48, s4
    s_mov_b32 s49, s5
    s_mov_b32 s50, 2621440
    s_mov_b32 s51, 0x20000
    s_cmp_eq_u32 s40, 0
    s_cselect_b32 s52, s10, s12
    s_cselect_b32 s53, s11, s13
    s_mov_b32 s54, 819200
    s_mov_b32 s55, 0x20000
    s_add_u32 m0, s69, 0
    s_nop 0
    buffer_load_dwordx4 v10, s[48:51], s68 offen offset:0 lds
    buffer_load_dwordx4 v11, s[48:51], s68 offen offset:1024 lds
    buffer_load_dwordx4 v12, s[48:51], s68 offen offset:2048 lds
    buffer_load_dwordx4 v13, s[48:51], s68 offen offset:3072 lds
    s_add_u32 m0, s70, 0
    s_nop 0
    buffer_load_dwordx4 v14, s[52:55], s68 offen offset:0 lds
    buffer_load_dwordx4 v15, s[52:55], s68 offen offset:1024 lds
    buffer_load_dwordx4 v16, s[52:55], s68 offen offset:2048 lds
    buffer_load_dwordx4 v17, s[52:55], s68 offen offset:3072 lds
    global_load_ushort v61, v60, s[6:7]
    global_load_ushort v62, v60, s[8:9]
    global_load_ushort v63, v60, s[18:19]
    s_lshr_b32 s44, s2, 3
    s_or_b32 s44, s44, s38
    s_cmp_lg_u32 s44, 0
    s_cbranch_scc1 L_no_offer_ssm
    s_memrealtime s[44:45]
    s_waitcnt lgkmcnt(0)
    s_or_b32 s44, s44, 1
    v_mov_b32 v124, s44
    v_mov_b32 v125, 0
    v_mov_b32 v122, 0
    s_mov_b64 exec, 1
    global_atomic_cmpswap v122, v[124:125], s[32:33] sc1
    s_mov_b64 exec, -1
L_no_offer_ssm:
    s_mov_b32 s56, s34
    s_mov_b32 s57, s35
    s_mov_b32 s58, 33554432
    s_mov_b32 s59, 0x20000
    s_and_b32 s44, s2, 3
    s_lshl_b32 s44, s44, 3
    s_bfe_u32 s45, s2, 0x30003
    s_add_u32 s22, s44, s45
    s_bfe_u32 s44, s2, 0x10002
    s_lshl_b32 s44, s44, 2
    s_lshr_b32 s45, s2, 6
    s_add_u32 s23, s44, s45
    v_and_b32 v9, 31, v1
    s_add_u32 s68, s68, 128
    s_cmp_eq_u32 s68, 1280
    s_cselect_b32 s68, 0, s68
    s_add_u32 m0, s69, 32768
    s_nop 0
    buffer_load_dwordx4 v10, s[48:51], s68 offen offset:0 lds
    v_lshrrev_b32 v2, 5, v1
    v_bfe_u32 v8, v1, 1, 3
    v_xor_b32 v2, v2, v8
    v_lshlrev_b32 v2, 4, v2
    v_lshl_add_u32 v2, v9, 7, v2
    s_lshl_b32 s41, s39, 13
    s_lshl_b32 s42, s40, 13
    s_add_u32 s42, s42, 16384
    v_mov_b32 v8, v2
    v_add_u32 v18, s41, v8
    v_add_u32 v22, s42, v8
    v_add_u32 v26, 65536, v18
    buffer_load_dwordx4 v11, s[48:51], s68 offen offset:1024 lds
    v_add_u32 v30, 65536, v22
    v_add_u32 v34, 131072, v18
    v_add_u32 v38, 131072, v22
    v_xor_b32 v8, 32, v2
    v_add_u32 v19, s41, v8
    v_add_u32 v23, s42, v8
    v_add_u32 v27, 65536, v19
    v_add_u32 v31, 65536, v23
    v_add_u32 v35, 131072, v19
    v_add_u32 v39, 131072, v23
    v_xor_b32 v8, 64, v2
    v_add_u32 v20, s41, v8
    buffer_load_dwordx4 v12, s[48:51], s68 offen offset:2048 lds
    v_add_u32 v24, s42, v8
    v_add_u32 v28, 65536, v20
    v_add_u32 v32, 65536, v24
    v_add_u32 v36, 131072, v20
    v_add_u32 v40, 131072, v24
    v_xor_b32 v8, 96, v2
    v_add_u32 v21, s41, v8
    v_add_u32 v25, s42, v8
    v_add_u32 v29, 65536, v21
    v_add_u32 v33, 65536, v25
    v_add_u32 v37, 131072, v21
    v_add_u32 v41, 131072, v25
    buffer_load_dwordx4 v13, s[48:51], s68 offen offset:3072 lds
    s_and_b32 s41, s36, 3
    s_mul_i32 s41, s41, 10
    s_add_u32 s41, s41, s37
    s_lshl_b32 s41, s41, 2
    s_add_u32 s41, s41, s38
    s_lshr_b32 s42, s36, 2
    s_add_u32 s43, s41, 0
    s_mul_i32 s44, s43, 13108
    s_lshr_b32 s44, s44, 16
    s_mul_i32 s45, s44, 5
    s_sub_u32 s45, s43, s45
    s_mul_i32 s46, s42, 5
    s_add_u32 m0, s70, 32768
    s_nop 0
    buffer_load_dwordx4 v14, s[52:55], s68 offen offset:0 lds
    s_add_u32 s45, s45, s46
    s_mul_i32 s74, s44, 40960
    s_lshl_b32 s46, s45, 6
    s_add_u32 s74, s74, s46
    s_add_u32 s44, s44, 40
    s_mul_i32 s44, s44, 5
    s_lshl_b32 s46, s45, 1
    s_mul_i32 s76, s46, 13108
    s_lshr_b32 s76, s76, 16
    s_mul_i32 s76, s76, 435
    s_add_u32 s76, s76, s46
    s_add_u32 s76, s76, s44
    s_lshl_b32 s76, s76, 10
    buffer_load_dwordx4 v15, s[52:55], s68 offen offset:1024 lds
    s_add_u32 s76, s76, 11534336
    s_lshl_b32 s46, s45, 1
    s_add_u32 s46, s46, 1
    s_mul_i32 s77, s46, 13108
    s_lshr_b32 s77, s77, 16
    s_mul_i32 s77, s77, 435
    s_add_u32 s77, s77, s46
    s_add_u32 s77, s77, s44
    s_lshl_b32 s77, s77, 10
    s_add_u32 s77, s77, 11534336
    s_add_u32 s43, s41, 160
    s_mul_i32 s44, s43, 13108
    buffer_load_dwordx4 v16, s[52:55], s68 offen offset:2048 lds
    s_lshr_b32 s44, s44, 16
    s_mul_i32 s45, s44, 5
    s_sub_u32 s45, s43, s45
    s_mul_i32 s46, s42, 5
    s_add_u32 s45, s45, s46
    s_mul_i32 s75, s44, 40960
    s_lshl_b32 s46, s45, 6
    s_add_u32 s75, s75, s46
    s_add_u32 s44, s44, 40
    s_mul_i32 s44, s44, 5
    s_lshl_b32 s46, s45, 1
    s_mul_i32 s78, s46, 13108
    buffer_load_dwordx4 v17, s[52:55], s68 offen offset:3072 lds
    s_lshr_b32 s78, s78, 16
    s_mul_i32 s78, s78, 435
    s_add_u32 s78, s78, s46
    s_add_u32 s78, s78, s44
    s_lshl_b32 s78, s78, 10
    s_add_u32 s78, s78, 11534336
    s_lshl_b32 s46, s45, 1
    s_add_u32 s46, s46, 1
    s_mul_i32 s79, s46, 13108
    s_lshr_b32 s79, s79, 16
    s_mul_i32 s79, s79, 435
    s_add_u32 s79, s79, s46
    s_add_u32 s68, s68, 128
    s_cmp_eq_u32 s68, 1280
    s_cselect_b32 s68, 0, s68
    s_add_u32 m0, s69, 65536
    s_nop 0
    buffer_load_dwordx4 v10, s[48:51], s68 offen offset:0 lds
    s_add_u32 s79, s79, s44
    s_lshl_b32 s79, s79, 10
    s_add_u32 s79, s79, 11534336
    s_cmp_ge_u32 s43, 240
    s_cselect_b32 s75, 2130706432, s75
    s_cselect_b32 s78, 2130706432, s78
    s_cselect_b32 s79, 2130706432, s79
    s_add_u32 s43, s41, 0
    s_mul_i32 s44, s43, 6554
    s_lshr_b32 s44, s44, 16
    s_mul_i32 s45, s44, 10
    s_sub_u32 s45, s43, s45
    s_mul_i32 s46, s42, 10
    s_add_u32 s45, s45, s46
    s_mul_i32 s80, s45, 20480
    buffer_load_dwordx4 v11, s[48:51], s68 offen offset:1024 lds
    s_lshl_b32 s46, s44, 6
    s_add_u32 s80, s80, s46
    s_mul_i32 s82, s45, 13108
    s_lshr_b32 s82, s82, 16
    s_mul_i32 s82, s82, 435
    s_add_u32 s82, s82, s45
    s_mul_i32 s46, s44, 10
    s_add_u32 s82, s82, s46
    s_lshl_b32 s82, s82, 10
    s_add_u32 s82, s82, 11534336
    s_add_u32 s83, s82, 5120
    s_add_u32 s43, s41, 160
    buffer_load_dwordx4 v12, s[48:51], s68 offen offset:2048 lds
    s_mul_i32 s44, s43, 6554
    s_lshr_b32 s44, s44, 16
    s_mul_i32 s45, s44, 10
    s_sub_u32 s45, s43, s45
    s_mul_i32 s46, s42, 10
    s_add_u32 s45, s45, s46
    s_mul_i32 s81, s45, 20480
    s_lshl_b32 s46, s44, 6
    s_add_u32 s81, s81, s46
    s_mul_i32 s88, s45, 13108
    s_lshr_b32 s88, s88, 16
    s_mul_i32 s88, s88, 435
    s_add_u32 s88, s88, s45
    buffer_load_dwordx4 v13, s[48:51], s68 offen offset:3072 lds
    s_mul_i32 s46, s44, 10
    s_add_u32 s88, s88, s46
    s_lshl_b32 s88, s88, 10
    s_add_u32 s88, s88, 11534336
    s_add_u32 s89, s88, 5120
    s_cmp_ge_u32 s43, 200
    s_cselect_b32 s81, 2130706432, s81
    s_cselect_b32 s88, 2130706432, s88
    s_cselect_b32 s89, 2130706432, s89
    s_lshl_b32 s93, s38, 13
    s_add_u32 s93, s93, 0
    s_lshl_b32 s99, s36, 4
    s_add_u32 s99, s99, s37
    s_lshl_b32 s99, s99, 7
    s_add_u32 s99, s99, 15343616
    s_add_u32 m0, s70, 65536
    s_nop 0
    buffer_load_dwordx4 v14, s[52:55], s68 offen offset:0 lds
    v_lshrrev_b32 v2, 2, v1
    v_mul_u32_u24 v2, 1280, v2
    v_and_b32 v3, 3, v1
    v_lshl_add_u32 v120, v3, 4, v2
    v_add_u32 v121, 19456, v120
    s_lshl_b32 s41, s36, 7
    s_lshl_b32 s42, s37, 4
    s_add_u32 s41, s41, s42
    s_lshl_b32 s42, s38, 2
    s_add_u32 s41, s41, s42
    s_mul_i32 s90, s41, 1280
    s_lshl_b32 s18, s41, 2
    buffer_load_dwordx4 v15, s[52:55], s68 offen offset:1024 lds
    s_add_u32 s18, s18, 15138816
    s_cmp_ge_u32 s37, 8
    s_cselect_b32 s90, 2130706432, s90
    s_cselect_b32 s18, 2130706432, s18
    s_add_u32 s91, s90, 4096
    v_mov_b32 v228, v1
    v_lshlrev_b32 v228, 4, v228
    v_add_u32 v232, 64, v1
    v_cmp_le_u32 vcc, 16, v1
    v_subrev_u32 v2, 80, v232
    s_nop 0
    v_cndmask_b32 v232, v232, v2, vcc
    v_lshlrev_b32 v232, 4, v232
    v_add_u32 v236, 48, v1
    buffer_load_dwordx4 v16, s[52:55], s68 offen offset:2048 lds
    v_cmp_le_u32 vcc, 32, v1
    v_subrev_u32 v2, 80, v236
    s_nop 0
    v_cndmask_b32 v236, v236, v2, vcc
    v_lshlrev_b32 v236, 4, v236
    v_add_u32 v240, 32, v1
    v_cmp_le_u32 vcc, 48, v1
    v_subrev_u32 v2, 80, v240
    s_nop 0
    v_cndmask_b32 v240, v240, v2, vcc
    v_lshlrev_b32 v240, 4, v240
    v_add_u32 v244, 16, v1
    buffer_load_dwordx4 v17, s[52:55], s68 offen offset:3072 lds
    v_lshlrev_b32 v244, 4, v244
    v_min_u32 v2, 39, v1
    v_mul_u32_u24 v3, 0x199a, v2
    v_lshrrev_b32 v3, 16, v3
    v_mul_u32_u24 v251, 10, v3
    v_sub_u32 v2, v2, v251
    s_lshr_b32 s41, s23, 1
    s_lshl_b32 s41, s41, 2
    v_add_u32 v3, s41, v3
    v_lshl_add_u32 v251, v3, 4, v2
    v_lshlrev_b32 v251, 7, v251
    v_add_u32 v251, 15343616, v251
    s_waitcnt vmcnt(19)
    s_barrier
    ds_read_b128 a[0:3], v18 offset:0
    ds_read_b128 a[16:19], v18 offset:4096
    ds_read_b128 a[32:35], v22 offset:0
    ds_read_b128 a[48:51], v22 offset:4096
    ds_read_b128 a[4:7], v19 offset:0
    ds_read_b128 a[20:23], v19 offset:4096
    ds_read_b128 a[36:39], v23 offset:0
    ds_read_b128 a[52:55], v23 offset:4096
    ds_read_b128 a[8:11], v20 offset:0
    ds_read_b128 a[24:27], v20 offset:4096
    ds_read_b128 a[40:43], v24 offset:0
    ds_read_b128 a[56:59], v24 offset:4096
    ds_read_b128 a[12:15], v21 offset:0
    ds_read_b128 a[28:31], v21 offset:4096
    ds_read_b128 a[44:47], v25 offset:0
    ds_read_b128 a[60:63], v25 offset:4096
    s_waitcnt lgkmcnt(0)
    v_mfma_f32_32x32x16_bf16 v[128:143], a[0:3], a[32:35], 0
    v_mfma_f32_32x32x16_bf16 v[144:159], a[0:3], a[48:51], 0
    s_waitcnt vmcnt(8)
    s_barrier
    v_mfma_f32_32x32x16_bf16 v[160:175], a[16:19], a[32:35], 0
    v_lshlrev_b32 v3, 16, v61
    v_lshlrev_b32 v4, 16, v62
    v_lshlrev_b32 v5, 16, v63
    v_mul_f32 v5, 0x3fb8aa3b, v5
    ds_read_b128 a[64:67], v18 offset:32768
    ds_read_b128 a[80:83], v18 offset:36864
    s_add_u32 s68, s68, 128
    s_cmp_eq_u32 s68, 1280
    s_cselect_b32 s68, 0, s68
    s_add_u32 m0, s69, 98304
    s_nop 0
    buffer_load_dwordx4 v10, s[48:51], s68 offen offset:0 lds
    buffer_load_dwordx4 v11, s[48:51], s68 offen offset:1024 lds
    v_mfma_f32_32x32x16_bf16 v[176:191], a[16:19], a[48:51], 0
    v_exp_f32 v5, v5
    s_nop 0
    v_cvt_pk_bf16_f32 v5, v5, v5
    v_lshlrev_b32 v5, 16, v5
    ds_read_b128 a[96:99], v22 offset:32768
    ds_read_b128 a[112:115], v22 offset:36864
    buffer_load_dwordx4 v12, s[48:51], s68 offen offset:2048 lds
    v_mfma_f32_32x32x16_bf16 v[128:143], a[4:7], a[36:39], v[128:143]
    v_mul_f32 v60, v5, v3
    v_mul_f32 v61, v5, v4
    v_mul_f32 v60, 0x3fb8aa3b, v60
    v_exp_f32 v60, v60
    ds_read_b128 a[68:71], v19 offset:32768
    ds_read_b128 a[84:87], v19 offset:36864
    buffer_load_dwordx4 v13, s[48:51], s68 offen offset:3072 lds
    v_mfma_f32_32x32x16_bf16 v[144:159], a[4:7], a[52:55], v[144:159]
    v_mul_f32 v61, 0.15915494, v61
    v_rndne_f32 v62, v61
    v_sub_f32 v61, v61, v62
    v_cos_f32 v62, v61
    ds_read_b128 a[100:103], v23 offset:32768
    ds_read_b128 a[116:119], v23 offset:36864
    s_add_u32 m0, s70, 98304
    s_nop 0
    buffer_load_dwordx4 v14, s[52:55], s68 offen offset:0 lds
    v_mfma_f32_32x32x16_bf16 v[160:175], a[20:23], a[36:39], v[160:175]
    v_sin_f32 v63, v61
    s_nop 0
    v_mul_f32 v42, v60, v62
    v_mul_f32 v43, v60, v63
    ds_read_b128 a[72:75], v20 offset:32768
    ds_read_b128 a[88:91], v20 offset:36864
    buffer_load_dwordx4 v15, s[52:55], s68 offen offset:1024 lds
    v_mfma_f32_32x32x16_bf16 v[176:191], a[20:23], a[52:55], v[176:191]
    v_add_f32 v60, -1.0, v42
    v_mul_f32 v62, v3, v3
    v_fmac_f32 v62, v4, v4
    v_rcp_f32 v62, v62
    ds_read_b128 a[104:107], v24 offset:32768
    ds_read_b128 a[120:123], v24 offset:36864
    buffer_load_dwordx4 v16, s[52:55], s68 offen offset:2048 lds
    v_mfma_f32_32x32x16_bf16 v[128:143], a[8:11], a[40:43], v[128:143]
    v_mul_f32 v50, v60, v3
    v_fmac_f32 v50, v43, v4
    v_mul_f32 v51, v43, v3
    v_fma_f32 v51, -v60, v4, v51
    ds_read_b128 a[76:79], v21 offset:32768
    ds_read_b128 a[92:95], v21 offset:36864
    buffer_load_dwordx4 v17, s[52:55], s68 offen offset:3072 lds
    v_mfma_f32_32x32x16_bf16 v[144:159], a[8:11], a[56:59], v[144:159]
    v_add_f32 v62, v62, v62
    v_mul_f32 v50, v50, v62
    v_mul_f32 v51, v51, v62
    v_mul_f32 v64, v42, v42
    ds_read_b128 a[108:111], v25 offset:32768
    ds_read_b128 a[124:127], v25 offset:36864
    s_add_u32 s68, s68, 128
    s_cmp_eq_u32 s68, 1280
    s_cselect_b32 s68, 0, s68
    s_add_u32 m0, s69, 131072
    s_nop 0
    buffer_load_dwordx4 v10, s[48:51], s68 offen offset:0 lds
    buffer_load_dwordx4 v11, s[48:51], s68 offen offset:1024 lds
    v_mfma_f32_32x32x16_bf16 v[160:175], a[24:27], a[40:43], v[160:175]
    v_mul_f32 v65, v42, v43
    v_fma_f32 v64, -v43, v43, v64
    v_add_f32 v65, v65, v65
    v_mul_f32 v66, v64, v64
    buffer_load_dwordx4 v12, s[48:51], s68 offen offset:2048 lds
    v_mfma_f32_32x32x16_bf16 v[176:191], a[24:27], a[56:59], v[176:191]
    v_mul_f32 v67, v64, v65
    v_fma_f32 v66, -v65, v65, v66
    v_add_f32 v67, v67, v67
    buffer_load_dwordx4 v13, s[48:51], s68 offen offset:3072 lds
    v_mfma_f32_32x32x16_bf16 v[128:143], a[12:15], a[44:47], v[128:143]
    v_mul_f32 v64, v66, v66
    v_mul_f32 v65, v66, v67
    v_fma_f32 v64, -v67, v67, v64
    v_add_f32 v65, v65, v65
    s_add_u32 m0, s70, 131072
    s_nop 0
    buffer_load_dwordx4 v14, s[52:55], s68 offen offset:0 lds
    v_mfma_f32_32x32x16_bf16 v[144:159], a[12:15], a[60:63], v[144:159]
    v_mul_f32 v44, v64, v64
    v_mul_f32 v45, v64, v65
    v_fma_f32 v44, -v65, v65, v44
    v_add_f32 v45, v45, v45
    buffer_load_dwordx4 v15, s[52:55], s68 offen offset:1024 lds
    v_mfma_f32_32x32x16_bf16 v[160:175], a[28:31], a[44:47], v[160:175]
    v_mul_f32 v68, v44, v44
    v_mul_f32 v69, v44, v45
    v_fma_f32 v68, -v45, v45, v68
    v_add_f32 v69, v69, v69
    buffer_load_dwordx4 v16, s[52:55], s68 offen offset:2048 lds
    v_mfma_f32_32x32x16_bf16 v[176:191], a[28:31], a[60:63], v[176:191]
    v_mul_f32 v70, v68, v68
    v_mul_f32 v71, v68, v69
    v_fma_f32 v70, -v69, v69, v70
    v_add_f32 v71, v71, v71
    buffer_load_dwordx4 v17, s[52:55], s68 offen offset:3072 lds
    s_waitcnt lgkmcnt(0)
    v_mfma_f32_32x32x16_bf16 v[128:143], a[64:67], a[96:99], v[128:143]
    v_mfma_f32_32x32x16_bf16 v[144:159], a[64:67], a[112:115], v[144:159]
    s_waitcnt vmcnt(16)
    s_barrier
    v_mfma_f32_32x32x16_bf16 v[160:175], a[80:83], a[96:99], v[160:175]
    v_mul_f32 v46, v70, v70
    v_mul_f32 v47, v70, v71
    v_fma_f32 v46, -v71, v71, v46
    v_add_f32 v47, v47, v47
    ds_read_b128 a[0:3], v26 offset:0
    ds_read_b128 a[16:19], v26 offset:4096
    s_add_u32 s68, s68, 128
    s_cmp_eq_u32 s68, 1280
    s_cselect_b32 s68, 0, s68
    s_add_u32 m0, s69, 0
    s_nop 0
    buffer_load_dwordx4 v10, s[48:51], s68 offen offset:0 lds
    buffer_load_dwordx4 v11, s[48:51], s68 offen offset:1024 lds
    v_mfma_f32_32x32x16_bf16 v[176:191], a[80:83], a[112:115], v[176:191]
    v_mul_f32 v48, v46, v46
    v_mul_f32 v49, v46, v47
    v_fma_f32 v48, -v47, v47, v48
    v_add_f32 v49, v49, v49
    ds_read_b128 a[32:35], v30 offset:0
    ds_read_b128 a[48:51], v30 offset:4096
    buffer_load_dwordx4 v12, s[48:51], s68 offen offset:2048 lds
    v_mfma_f32_32x32x16_bf16 v[128:143], a[68:71], a[100:103], v[128:143]
    v_cmp_lt_u32 vcc, 31, v1
    s_cmp_eq_u32 s39, 1
    s_cselect_b64 s[94:95], -1, 0
    v_mov_b32 v64, 1.0
    v_mov_b32 v65, 0
    ds_read_b128 a[4:7], v27 offset:0
    ds_read_b128 a[20:23], v27 offset:4096
    buffer_load_dwordx4 v13, s[48:51], s68 offen offset:3072 lds
    v_mfma_f32_32x32x16_bf16 v[144:159], a[68:71], a[116:119], v[144:159]
    v_cndmask_b32 v66, v64, v68, vcc
    v_cndmask_b32 v67, v65, v69, vcc
    v_cndmask_b32 v64, v64, v70, s[94:95]
    v_cndmask_b32 v65, v65, v71, s[94:95]
    ds_read_b128 a[36:39], v31 offset:0
    ds_read_b128 a[52:55], v31 offset:4096
    s_add_u32 m0, s70, 0
    s_nop 0
    buffer_load_dwordx4 v14, s[52:55], s68 offen offset:0 lds
    v_mfma_f32_32x32x16_bf16 v[160:175], a[84:87], a[100:103], v[160:175]
    v_mul_f32 v52, v64, v66
    v_mul_f32 v54, v64, v67
    v_fma_f32 v52, -v65, v67, v52
    ds_read_b128 a[8:11], v28 offset:0
    ds_read_b128 a[24:27], v28 offset:4096
    buffer_load_dwordx4 v15, s[52:55], s68 offen offset:1024 lds
    v_mfma_f32_32x32x16_bf16 v[176:191], a[84:87], a[116:119], v[176:191]
    v_fma_f32 v54, v65, v66, v54
    v_mul_f32 v53, v52, v44
    v_mul_f32 v55, v52, v45
    v_fma_f32 v53, -v54, v45, v53
    ds_read_b128 a[40:43], v32 offset:0
    ds_read_b128 a[56:59], v32 offset:4096
    buffer_load_dwordx4 v16, s[52:55], s68 offen offset:2048 lds
    v_mfma_f32_32x32x16_bf16 v[128:143], a[72:75], a[104:107], v[128:143]
    v_fma_f32 v55, v54, v44, v55
    v_and_b32 v2, 31, v1
    v_lshrrev_b32 v3, 2, v2
    v_lshlrev_b32 v3, 4, v3
    ds_read_b128 a[12:15], v29 offset:0
    ds_read_b128 a[28:31], v29 offset:4096
    buffer_load_dwordx4 v17, s[52:55], s68 offen offset:3072 lds
    v_mfma_f32_32x32x16_bf16 v[144:159], a[72:75], a[120:123], v[144:159]
    v_and_b32 v2, 3, v2
    v_lshl_add_u32 v3, v2, 2, v3
    v_lshrrev_b32 v2, 5, v1
    v_lshl_add_u32 v3, v2, 11, v3
    ds_read_b128 a[44:47], v33 offset:0
    ds_read_b128 a[60:63], v33 offset:4096
    s_add_u32 s68, s68, 128
    s_cmp_eq_u32 s68, 1280
    s_cselect_b32 s68, 0, s68
    s_add_u32 m0, s69, 32768
    s_nop 0
    buffer_load_dwordx4 v10, s[48:51], s68 offen offset:0 lds
    buffer_load_dwordx4 v11, s[48:51], s68 offen offset:1024 lds
    v_mfma_f32_32x32x16_bf16 v[160:175], a[88:91], a[104:107], v[160:175]
    s_lshl_b32 s41, s38, 13
    s_add_u32 s41, s41, 65536
    v_add_u32 v3, s41, v3
    v_xor_b32 v192, 0, v3
    buffer_load_dwordx4 v12, s[48:51], s68 offen offset:2048 lds
    v_mfma_f32_32x32x16_bf16 v[176:191], a[88:91], a[120:123], v[176:191]
    v_xor_b32 v193, 128, v3
    v_xor_b32 v194, 272, v3
    v_xor_b32 v195, 400, v3
    v_xor_b32 v196, 544, v3
    buffer_load_dwordx4 v13, s[48:51], s68 offen offset:3072 lds
    v_mfma_f32_32x32x16_bf16 v[128:143], a[76:79], a[108:111], v[128:143]
    v_xor_b32 v197, 672, v3
    v_xor_b32 v198, 816, v3
    v_xor_b32 v199, 944, v3
    v_xor_b32 v200, 1088, v3
    s_add_u32 m0, s70, 32768
    s_nop 0
    buffer_load_dwordx4 v14, s[52:55], s68 offen offset:0 lds
    v_mfma_f32_32x32x16_bf16 v[144:159], a[76:79], a[124:127], v[144:159]
    v_xor_b32 v201, 1216, v3
    v_xor_b32 v202, 1360, v3
    v_xor_b32 v203, 1488, v3
    v_xor_b32 v204, 1632, v3
    buffer_load_dwordx4 v15, s[52:55], s68 offen offset:1024 lds
    v_mfma_f32_32x32x16_bf16 v[160:175], a[92:95], a[108:111], v[160:175]
    v_xor_b32 v205, 1760, v3
    v_xor_b32 v206, 1904, v3
    v_xor_b32 v207, 2032, v3
    s_lshl_b32 s98, s36, 4
    buffer_load_dwordx4 v16, s[52:55], s68 offen offset:2048 lds
    v_mfma_f32_32x32x16_bf16 v[176:191], a[92:95], a[124:127], v[176:191]
    s_add_u32 s98, s98, s37
    s_lshl_b32 s98, s98, 7
    s_add_u32 s98, s98, 15310848
    buffer_load_dwordx4 v17, s[52:55], s68 offen offset:3072 lds
    s_waitcnt lgkmcnt(0)
    v_mfma_f32_32x32x16_bf16 v[128:143], a[0:3], a[32:35], v[128:143]
    v_mfma_f32_32x32x16_bf16 v[144:159], a[0:3], a[48:51], v[144:159]
    s_waitcnt vmcnt(24)
    s_barrier
    v_mfma_f32_32x32x16_bf16 v[160:175], a[16:19], a[32:35], v[160:175]
    ds_read_b128 a[64:67], v26 offset:32768
    ds_read_b128 a[80:83], v26 offset:36864
    s_add_u32 s68, s68, 128
    s_cmp_eq_u32 s68, 1280
    s_cselect_b32 s68, 0, s68
    s_add_u32 m0, s69, 65536
    s_nop 0
    buffer_load_dwordx4 v10, s[48:51], s68 offen offset:0 lds
    v_mfma_f32_32x32x16_bf16 v[176:191], a[16:19], a[48:51], v[176:191]
    ds_read_b128 a[96:99], v30 offset:32768
    ds_read_b128 a[112:115], v30 offset:36864
    v_mfma_f32_32x32x16_bf16 v[128:143], a[4:7], a[36:39], v[128:143]
    ds_read_b128 a[68:71], v27 offset:32768
    ds_read_b128 a[84:87], v27 offset:36864
    buffer_load_dwordx4 v11, s[48:51], s68 offen offset:1024 lds
    v_mfma_f32_32x32x16_bf16 v[144:159], a[4:7], a[52:55], v[144:159]
    ds_read_b128 a[100:103], v31 offset:32768
    ds_read_b128 a[116:119], v31 offset:36864
    v_mfma_f32_32x32x16_bf16 v[160:175], a[20:23], a[36:39], v[160:175]
    ds_read_b128 a[72:75], v28 offset:32768
    ds_read_b128 a[88:91], v28 offset:36864
    buffer_load_dwordx4 v12, s[48:51], s68 offen offset:2048 lds
    v_mfma_f32_32x32x16_bf16 v[176:191], a[20:23], a[52:55], v[176:191]
    ds_read_b128 a[104:107], v32 offset:32768
    ds_read_b128 a[120:123], v32 offset:36864
    v_mfma_f32_32x32x16_bf16 v[128:143], a[8:11], a[40:43], v[128:143]
    ds_read_b128 a[76:79], v29 offset:32768
    ds_read_b128 a[92:95], v29 offset:36864
    buffer_load_dwordx4 v13, s[48:51], s68 offen offset:3072 lds
    v_mfma_f32_32x32x16_bf16 v[144:159], a[8:11], a[56:59], v[144:159]
    ds_read_b128 a[108:111], v33 offset:32768
    ds_read_b128 a[124:127], v33 offset:36864
    v_mfma_f32_32x32x16_bf16 v[160:175], a[24:27], a[40:43], v[160:175]
    s_add_u32 m0, s70, 65536
    s_nop 0
    buffer_load_dwordx4 v14, s[52:55], s68 offen offset:0 lds
    v_mfma_f32_32x32x16_bf16 v[176:191], a[24:27], a[56:59], v[176:191]
    v_mfma_f32_32x32x16_bf16 v[128:143], a[12:15], a[44:47], v[128:143]
    buffer_load_dwordx4 v15, s[52:55], s68 offen offset:1024 lds
    v_mfma_f32_32x32x16_bf16 v[144:159], a[12:15], a[60:63], v[144:159]
    v_mfma_f32_32x32x16_bf16 v[160:175], a[28:31], a[44:47], v[160:175]
    buffer_load_dwordx4 v16, s[52:55], s68 offen offset:2048 lds
    v_mfma_f32_32x32x16_bf16 v[176:191], a[28:31], a[60:63], v[176:191]
    buffer_load_dwordx4 v17, s[52:55], s68 offen offset:3072 lds
    s_waitcnt lgkmcnt(0)
    v_mfma_f32_32x32x16_bf16 v[128:143], a[64:67], a[96:99], v[128:143]
    v_mfma_f32_32x32x16_bf16 v[144:159], a[64:67], a[112:115], v[144:159]
    s_waitcnt vmcnt(24)
    s_barrier
    v_mfma_f32_32x32x16_bf16 v[160:175], a[80:83], a[96:99], v[160:175]
    ds_read_b128 a[0:3], v34 offset:0
    ds_read_b128 a[16:19], v34 offset:4096
    s_add_u32 s68, s68, 128
    s_cmp_eq_u32 s68, 1280
    s_cselect_b32 s68, 0, s68
    s_add_u32 m0, s69, 98304
    s_nop 0
    buffer_load_dwordx4 v10, s[48:51], s68 offen offset:0 lds
    v_mfma_f32_32x32x16_bf16 v[176:191], a[80:83], a[112:115], v[176:191]
    ds_read_b128 a[32:35], v38 offset:0
    ds_read_b128 a[48:51], v38 offset:4096
    v_mfma_f32_32x32x16_bf16 v[128:143], a[68:71], a[100:103], v[128:143]
    ds_read_b128 a[4:7], v35 offset:0
    ds_read_b128 a[20:23], v35 offset:4096
    buffer_load_dwordx4 v11, s[48:51], s68 offen offset:1024 lds
    v_mfma_f32_32x32x16_bf16 v[144:159], a[68:71], a[116:119], v[144:159]
    ds_read_b128 a[36:39], v39 offset:0
    ds_read_b128 a[52:55], v39 offset:4096
    v_mfma_f32_32x32x16_bf16 v[160:175], a[84:87], a[100:103], v[160:175]
    ds_read_b128 a[8:11], v36 offset:0
    ds_read_b128 a[24:27], v36 offset:4096
    buffer_load_dwordx4 v12, s[48:51], s68 offen offset:2048 lds
    v_mfma_f32_32x32x16_bf16 v[176:191], a[84:87], a[116:119], v[176:191]
    ds_read_b128 a[40:43], v40 offset:0
    ds_read_b128 a[56:59], v40 offset:4096
    v_mfma_f32_32x32x16_bf16 v[128:143], a[72:75], a[104:107], v[128:143]
    ds_read_b128 a[12:15], v37 offset:0
    ds_read_b128 a[28:31], v37 offset:4096
    buffer_load_dwordx4 v13, s[48:51], s68 offen offset:3072 lds
    v_mfma_f32_32x32x16_bf16 v[144:159], a[72:75], a[120:123], v[144:159]
    ds_read_b128 a[44:47], v41 offset:0
    ds_read_b128 a[60:63], v41 offset:4096
    v_mfma_f32_32x32x16_bf16 v[160:175], a[88:91], a[104:107], v[160:175]
    s_add_u32 m0, s70, 98304
    s_nop 0
    buffer_load_dwordx4 v14, s[52:55], s68 offen offset:0 lds
    v_mfma_f32_32x32x16_bf16 v[176:191], a[88:91], a[120:123], v[176:191]
    v_mfma_f32_32x32x16_bf16 v[128:143], a[76:79], a[108:111], v[128:143]
    buffer_load_dwordx4 v15, s[52:55], s68 offen offset:1024 lds
    v_mfma_f32_32x32x16_bf16 v[144:159], a[76:79], a[124:127], v[144:159]
    v_mfma_f32_32x32x16_bf16 v[160:175], a[92:95], a[108:111], v[160:175]
    buffer_load_dwordx4 v16, s[52:55], s68 offen offset:2048 lds
    v_mfma_f32_32x32x16_bf16 v[176:191], a[92:95], a[124:127], v[176:191]
    buffer_load_dwordx4 v17, s[52:55], s68 offen offset:3072 lds
    s_waitcnt lgkmcnt(0)
    v_mfma_f32_32x32x16_bf16 v[128:143], a[0:3], a[32:35], v[128:143]
    v_mfma_f32_32x32x16_bf16 v[144:159], a[0:3], a[48:51], v[144:159]
    s_waitcnt vmcnt(24)
    s_barrier
    v_mfma_f32_32x32x16_bf16 v[160:175], a[16:19], a[32:35], v[160:175]
    ds_read_b128 a[64:67], v18 offset:0
    ds_read_b128 a[80:83], v18 offset:4096
    s_add_u32 s68, s68, 128
    s_cmp_eq_u32 s68, 1280
    s_cselect_b32 s68, 0, s68
    s_add_u32 m0, s69, 131072
    s_nop 0
    buffer_load_dwordx4 v10, s[48:51], s68 offen offset:0 lds
    v_mfma_f32_32x32x16_bf16 v[176:191], a[16:19], a[48:51], v[176:191]
    ds_read_b128 a[96:99], v22 offset:0
    ds_read_b128 a[112:115], v22 offset:4096
    v_mfma_f32_32x32x16_bf16 v[128:143], a[4:7], a[36:39], v[128:143]
    ds_read_b128 a[68:71], v19 offset:0
    ds_read_b128 a[84:87], v19 offset:4096
    buffer_load_dwordx4 v11, s[48:51], s68 offen offset:1024 lds
    v_mfma_f32_32x32x16_bf16 v[144:159], a[4:7], a[52:55], v[144:159]
    ds_read_b128 a[100:103], v23 offset:0
    ds_read_b128 a[116:119], v23 offset:4096
    v_mfma_f32_32x32x16_bf16 v[160:175], a[20:23], a[36:39], v[160:175]
    ds_read_b128 a[72:75], v20 offset:0
    ds_read_b128 a[88:91], v20 offset:4096
    buffer_load_dwordx4 v12, s[48:51], s68 offen offset:2048 lds
    v_mfma_f32_32x32x16_bf16 v[176:191], a[20:23], a[52:55], v[176:191]
    ds_read_b128 a[104:107], v24 offset:0
    ds_read_b128 a[120:123], v24 offset:4096
    v_mfma_f32_32x32x16_bf16 v[128:143], a[8:11], a[40:43], v[128:143]
    ds_read_b128 a[76:79], v21 offset:0
    ds_read_b128 a[92:95], v21 offset:4096
    buffer_load_dwordx4 v13, s[48:51], s68 offen offset:3072 lds
    v_mfma_f32_32x32x16_bf16 v[144:159], a[8:11], a[56:59], v[144:159]
    ds_read_b128 a[108:111], v25 offset:0
    ds_read_b128 a[124:127], v25 offset:4096
    v_mfma_f32_32x32x16_bf16 v[160:175], a[24:27], a[40:43], v[160:175]
    s_add_u32 m0, s70, 131072
    s_nop 0
    buffer_load_dwordx4 v14, s[52:55], s68 offen offset:0 lds
    v_mfma_f32_32x32x16_bf16 v[176:191], a[24:27], a[56:59], v[176:191]
    v_mfma_f32_32x32x16_bf16 v[128:143], a[12:15], a[44:47], v[128:143]
    buffer_load_dwordx4 v15, s[52:55], s68 offen offset:1024 lds
    v_mfma_f32_32x32x16_bf16 v[144:159], a[12:15], a[60:63], v[144:159]
    v_mfma_f32_32x32x16_bf16 v[160:175], a[28:31], a[44:47], v[160:175]
    buffer_load_dwordx4 v16, s[52:55], s68 offen offset:2048 lds
    v_mfma_f32_32x32x16_bf16 v[176:191], a[28:31], a[60:63], v[176:191]
    buffer_load_dwordx4 v17, s[52:55], s68 offen offset:3072 lds
    s_waitcnt lgkmcnt(0)
    v_mfma_f32_32x32x16_bf16 v[128:143], a[64:67], a[96:99], v[128:143]
    v_mfma_f32_32x32x16_bf16 v[144:159], a[64:67], a[112:115], v[144:159]
    s_waitcnt vmcnt(24)
    s_barrier
    v_mfma_f32_32x32x16_bf16 v[160:175], a[80:83], a[96:99], v[160:175]
    ds_read_b128 a[0:3], v18 offset:32768
    ds_read_b128 a[16:19], v18 offset:36864
    v_mfma_f32_32x32x16_bf16 v[176:191], a[80:83], a[112:115], v[176:191]
    ds_read_b128 a[32:35], v22 offset:32768
    ds_read_b128 a[48:51], v22 offset:36864
    v_mfma_f32_32x32x16_bf16 v[128:143], a[68:71], a[100:103], v[128:143]
    ds_read_b128 a[4:7], v19 offset:32768
    ds_read_b128 a[20:23], v19 offset:36864
    v_mfma_f32_32x32x16_bf16 v[144:159], a[68:71], a[116:119], v[144:159]
    ds_read_b128 a[36:39], v23 offset:32768
    ds_read_b128 a[52:55], v23 offset:36864
    v_mfma_f32_32x32x16_bf16 v[160:175], a[84:87], a[100:103], v[160:175]
    ds_read_b128 a[8:11], v20 offset:32768
    ds_read_b128 a[24:27], v20 offset:36864
    v_mfma_f32_32x32x16_bf16 v[176:191], a[84:87], a[116:119], v[176:191]
    ds_read_b128 a[40:43], v24 offset:32768
    ds_read_b128 a[56:59], v24 offset:36864
    v_mfma_f32_32x32x16_bf16 v[128:143], a[72:75], a[104:107], v[128:143]
    ds_read_b128 a[12:15], v21 offset:32768
    ds_read_b128 a[28:31], v21 offset:36864
    v_mfma_f32_32x32x16_bf16 v[144:159], a[72:75], a[120:123], v[144:159]
    ds_read_b128 a[44:47], v25 offset:32768
    ds_read_b128 a[60:63], v25 offset:36864
    v_mfma_f32_32x32x16_bf16 v[160:175], a[88:91], a[104:107], v[160:175]
    s_mov_b32 s60, s26
    s_mov_b32 s61, s27
    s_mov_b32 s62, 1966080
    s_mov_b32 s63, 0x20000
    s_mov_b32 s64, s14
    s_mov_b32 s65, s15
    s_mov_b32 s66, 819200
    s_mov_b32 s67, 0x20000
    s_add_u32 m0, s93, 0
    s_nop 0
    buffer_load_dwordx4 v120, s[60:63], s74 offen lds
    v_mfma_f32_32x32x16_bf16 v[176:191], a[88:91], a[120:123], v[176:191]
    buffer_load_dwordx4 v121, s[60:63], s74 offen offset:1024 lds
    v_mfma_f32_32x32x16_bf16 v[128:143], a[76:79], a[108:111], v[128:143]
    v_mfma_f32_32x32x16_bf16 v[144:159], a[76:79], a[124:127], v[144:159]
    s_add_u32 m0, s93, 2048
    s_nop 0
    buffer_load_dwordx4 v120, s[64:67], s80 offen lds
    v_mfma_f32_32x32x16_bf16 v[160:175], a[92:95], a[108:111], v[160:175]
    v_mfma_f32_32x32x16_bf16 v[176:191], a[92:95], a[124:127], v[176:191]
    s_add_u32 m0, s93, 4096
    s_nop 0
    buffer_load_dwordx4 v120, s[60:63], s75 offen lds
    s_waitcnt lgkmcnt(0)
    v_mfma_f32_32x32x16_bf16 v[128:143], a[0:3], a[32:35], v[128:143]
    v_mfma_f32_32x32x16_bf16 v[144:159], a[0:3], a[48:51], v[144:159]
    s_waitcnt vmcnt(20)
    s_barrier
    v_mfma_f32_32x32x16_bf16 v[160:175], a[16:19], a[32:35], v[160:175]
    ds_read_b128 a[64:67], v26 offset:0
    ds_read_b128 a[80:83], v26 offset:4096
    v_mfma_f32_32x32x16_bf16 v[176:191], a[16:19], a[48:51], v[176:191]
    ds_read_b128 a[96:99], v30 offset:0
    ds_read_b128 a[112:115], v30 offset:4096
    v_mfma_f32_32x32x16_bf16 v[128:143], a[4:7], a[36:39], v[128:143]
    ds_read_b128 a[68:71], v27 offset:0
    ds_read_b128 a[84:87], v27 offset:4096
    v_mfma_f32_32x32x16_bf16 v[144:159], a[4:7], a[52:55], v[144:159]
    ds_read_b128 a[100:103], v31 offset:0
    ds_read_b128 a[116:119], v31 offset:4096
    v_mfma_f32_32x32x16_bf16 v[160:175], a[20:23], a[36:39], v[160:175]
    ds_read_b128 a[72:75], v28 offset:0
    ds_read_b128 a[88:91], v28 offset:4096
    v_mfma_f32_32x32x16_bf16 v[176:191], a[20:23], a[52:55], v[176:191]
    ds_read_b128 a[104:107], v32 offset:0
    ds_read_b128 a[120:123], v32 offset:4096
    v_mfma_f32_32x32x16_bf16 v[128:143], a[8:11], a[40:43], v[128:143]
    s_mul_i32 s41, s38, 22
    s_mul_i32 s42, s23, 88
    s_add_u32 s42, s42, s41
    s_mul_i32 s42, s42, 5120
    s_add_u32 s42, s42, 11534336
    s_add_u32 s52, s34, s42
    s_addc_u32 s53, s35, 0
    s_mov_b32 s54, 112640
    s_mov_b32 s55, 0x20000
    ds_read_b128 a[76:79], v29 offset:0
    ds_read_b128 a[92:95], v29 offset:4096
    v_mfma_f32_32x32x16_bf16 v[144:159], a[8:11], a[56:59], v[144:159]
    ds_read_b128 a[108:111], v33 offset:0
    ds_read_b128 a[124:127], v33 offset:4096
    v_mfma_f32_32x32x16_bf16 v[160:175], a[24:27], a[40:43], v[160:175]
    buffer_load_dwordx4 v121, s[60:63], s75 offen offset:1024 lds
    v_mfma_f32_32x32x16_bf16 v[176:191], a[24:27], a[56:59], v[176:191]
    s_add_u32 m0, s93, 6144
    s_nop 0
    buffer_load_dwordx4 v120, s[64:67], s81 offen lds
    v_mfma_f32_32x32x16_bf16 v[128:143], a[12:15], a[44:47], v[128:143]
    v_mfma_f32_32x32x16_bf16 v[144:159], a[12:15], a[60:63], v[144:159]
    s_mov_b32 s60, s16
    s_mov_b32 s61, s17
    s_mov_b32 s62, 819200
    s_mov_b32 s63, 0x20000
    s_add_u32 m0, s93, 3072
    s_nop 0
    buffer_load_dwordx4 v120, s[60:63], s80 offen lds
    v_mfma_f32_32x32x16_bf16 v[160:175], a[28:31], a[44:47], v[160:175]
    v_mfma_f32_32x32x16_bf16 v[176:191], a[28:31], a[60:63], v[176:191]
    s_add_u32 m0, s93, 7168
    s_nop 0
    buffer_load_dwordx4 v120, s[60:63], s81 offen lds
    s_waitcnt lgkmcnt(0)
    v_mfma_f32_32x32x16_bf16 v[128:143], a[64:67], a[96:99], v[128:143]
    v_mfma_f32_32x32x16_bf16 v[144:159], a[64:67], a[112:115], v[144:159]
    s_waitcnt vmcnt(16)
    s_barrier
    v_mfma_f32_32x32x16_bf16 v[160:175], a[80:83], a[96:99], v[160:175]
    ds_read_b128 a[0:3], v26 offset:32768
    ds_read_b128 a[16:19], v26 offset:36864
    v_mfma_f32_32x32x16_bf16 v[176:191], a[80:83], a[112:115], v[176:191]
    ds_read_b128 a[32:35], v30 offset:32768
    ds_read_b128 a[48:51], v30 offset:36864
    v_mfma_f32_32x32x16_bf16 v[128:143], a[68:71], a[100:103], v[128:143]
    ds_read_b128 a[4:7], v27 offset:32768
    ds_read_b128 a[20:23], v27 offset:36864
    v_mfma_f32_32x32x16_bf16 v[144:159], a[68:71], a[116:119], v[144:159]
    ds_read_b128 a[36:39], v31 offset:32768
    ds_read_b128 a[52:55], v31 offset:36864
    v_mfma_f32_32x32x16_bf16 v[160:175], a[84:87], a[100:103], v[160:175]
    ds_read_b128 a[8:11], v28 offset:32768
    ds_read_b128 a[24:27], v28 offset:36864
    v_mfma_f32_32x32x16_bf16 v[176:191], a[84:87], a[116:119], v[176:191]
    ds_read_b128 a[40:43], v32 offset:32768
    ds_read_b128 a[56:59], v32 offset:36864
    v_mfma_f32_32x32x16_bf16 v[128:143], a[72:75], a[104:107], v[128:143]
    ds_read_b128 a[12:15], v29 offset:32768
    ds_read_b128 a[28:31], v29 offset:36864
    s_cmp_lg_u32 s38, 0
    s_cbranch_scc1 L_nl_252_868
    v_mov_b32 v253, 0
    global_load_dword v252, v253, s[32:33] sc0 sc1
L_nl_252_868:
    v_mfma_f32_32x32x16_bf16 v[144:159], a[72:75], a[120:123], v[144:159]
    ds_read_b128 a[44:47], v33 offset:32768
    ds_read_b128 a[60:63], v33 offset:36864
    v_mfma_f32_32x32x16_bf16 v[160:175], a[88:91], a[104:107], v[160:175]
    s_mov_b32 s60, s28
    s_mov_b32 s61, s29
    s_mov_b32 s62, 1280
    s_mov_b32 s63, 0x20000
    buffer_load_dwordx4 v[228:231], v228, s[60:63], 0 offen
    v_mfma_f32_32x32x16_bf16 v[176:191], a[88:91], a[120:123], v[176:191]
    buffer_load_dwordx4 v[232:235], v232, s[60:63], 0 offen
    v_mfma_f32_32x32x16_bf16 v[128:143], a[76:79], a[108:111], v[128:143]
    buffer_load_dwordx4 v[236:239], v236, s[60:63], 0 offen
    v_mfma_f32_32x32x16_bf16 v[144:159], a[76:79], a[124:127], v[144:159]
    v_mfma_f32_32x32x16_bf16 v[160:175], a[92:95], a[108:111], v[160:175]
    buffer_load_dwordx4 v[240:243], v240, s[60:63], 0 offen
    v_mfma_f32_32x32x16_bf16 v[176:191], a[92:95], a[124:127], v[176:191]
    buffer_load_dwordx4 v[244:247], v244, s[60:63], 0 offen
    s_waitcnt lgkmcnt(0)
    v_mfma_f32_32x32x16_bf16 v[128:143], a[0:3], a[32:35], v[128:143]
    v_mfma_f32_32x32x16_bf16 v[144:159], a[0:3], a[48:51], v[144:159]
    s_waitcnt vmcnt(13)
    s_barrier
    v_mfma_f32_32x32x16_bf16 v[160:175], a[16:19], a[32:35], v[160:175]
    ds_read_b128 a[64:67], v34 offset:0
    ds_read_b128 a[80:83], v34 offset:4096
    v_mfma_f32_32x32x16_bf16 v[176:191], a[16:19], a[48:51], v[176:191]
    ds_read_b128 a[96:99], v38 offset:0
    ds_read_b128 a[112:115], v38 offset:4096
    v_mfma_f32_32x32x16_bf16 v[128:143], a[4:7], a[36:39], v[128:143]
    ds_read_b128 a[68:71], v35 offset:0
    ds_read_b128 a[84:87], v35 offset:4096
    v_mfma_f32_32x32x16_bf16 v[144:159], a[4:7], a[52:55], v[144:159]
    ds_read_b128 a[100:103], v39 offset:0
    ds_read_b128 a[116:119], v39 offset:4096
    v_mfma_f32_32x32x16_bf16 v[160:175], a[20:23], a[36:39], v[160:175]
    ds_read_b128 a[72:75], v36 offset:0
    ds_read_b128 a[88:91], v36 offset:4096
    v_mfma_f32_32x32x16_bf16 v[176:191], a[20:23], a[52:55], v[176:191]
    ds_read_b128 a[104:107], v40 offset:0
    ds_read_b128 a[120:123], v40 offset:4096
    v_mfma_f32_32x32x16_bf16 v[128:143], a[8:11], a[40:43], v[128:143]
    ds_read_b128 a[76:79], v37 offset:0
    ds_read_b128 a[92:95], v37 offset:4096
    v_mfma_f32_32x32x16_bf16 v[144:159], a[8:11], a[56:59], v[144:159]
    ds_read_b128 a[108:111], v41 offset:0
    ds_read_b128 a[124:127], v41 offset:4096
    v_mfma_f32_32x32x16_bf16 v[160:175], a[24:27], a[40:43], v[160:175]
    buffer_load_dwordx4 v[208:211], v248, s[48:51], s90 offen offset:0
    v_mfma_f32_32x32x16_bf16 v[176:191], a[24:27], a[56:59], v[176:191]
    buffer_load_dwordx4 v[212:215], v248, s[48:51], s90 offen offset:1024
    v_mfma_f32_32x32x16_bf16 v[128:143], a[12:15], a[44:47], v[128:143]
    buffer_load_dwordx4 v[216:219], v248, s[48:51], s90 offen offset:2048
    v_mfma_f32_32x32x16_bf16 v[144:159], a[12:15], a[60:63], v[144:159]
    v_mfma_f32_32x32x16_bf16 v[160:175], a[28:31], a[44:47], v[160:175]
    buffer_load_dwordx4 v[220:223], v248, s[48:51], s90 offen offset:3072
    v_mfma_f32_32x32x16_bf16 v[176:191], a[28:31], a[60:63], v[176:191]
    buffer_load_dwordx4 v[224:227], v248, s[48:51], s91 offen offset:0
    s_waitcnt lgkmcnt(0)
    v_mfma_f32_32x32x16_bf16 v[128:143], a[64:67], a[96:99], v[128:143]
    v_mfma_f32_32x32x16_bf16 v[144:159], a[64:67], a[112:115], v[144:159]
    v_mfma_f32_32x32x16_bf16 v[128:143], a[68:71], a[100:103], v[128:143]
    v_mfma_f32_32x32x16_bf16 v[144:159], a[68:71], a[116:119], v[144:159]
    v_mfma_f32_32x32x16_bf16 v[128:143], a[72:75], a[104:107], v[128:143]
    v_mfma_f32_32x32x16_bf16 v[144:159], a[72:75], a[120:123], v[144:159]
    v_mfma_f32_32x32x16_bf16 v[128:143], a[76:79], a[108:111], v[128:143]
    v_mfma_f32_32x32x16_bf16 v[144:159], a[76:79], a[124:127], v[144:159]
    v_mfma_f32_32x32x16_bf16 v[160:175], a[80:83], a[96:99], v[160:175]
    v_mfma_f32_32x32x16_bf16 v[176:191], a[80:83], a[112:115], v[176:191]
    v_mfma_f32_32x32x16_bf16 v[160:175], a[84:87], a[100:103], v[160:175]
    v_mfma_f32_32x32x16_bf16 v[176:191], a[84:87], a[116:119], v[176:191]
    v_mfma_f32_32x32x16_bf16 v[160:175], a[88:91], a[104:107], v[160:175]
    v_mfma_f32_32x32x16_bf16 v[176:191], a[88:91], a[120:123], v[176:191]
    v_mfma_f32_32x32x16_bf16 v[160:175], a[92:95], a[108:111], v[160:175]
    v_mfma_f32_32x32x16_bf16 v[176:191], a[92:95], a[124:127], v[176:191]
    s_nop 7
    s_nop 3
    v_pk_fma_f32 v[60:61], v[42:43], v[144:145], v[130:131] op_sel:[1,0,0] op_sel_hi:[1,1,1] neg_lo:[1,0,0] neg_hi:[1,0,0]
    v_pk_fma_f32 v[62:63], v[42:43], v[128:129], v[146:147] op_sel:[1,0,0] op_sel_hi:[1,1,1]
    v_pk_fma_f32 v[56:57], v[42:43], v[128:129], v[60:61] op_sel:[0,0,0] op_sel_hi:[0,1,1]
    v_pk_fma_f32 v[58:59], v[42:43], v[144:145], v[62:63] op_sel:[0,0,0] op_sel_hi:[0,1,1]
    v_pk_fma_f32 v[60:61], v[42:43], v[58:59], v[132:133] op_sel:[1,0,0] op_sel_hi:[1,1,1] neg_lo:[1,0,0] neg_hi:[1,0,0]
    v_pk_fma_f32 v[62:63], v[42:43], v[56:57], v[148:149] op_sel:[1,0,0] op_sel_hi:[1,1,1]
    v_pk_fma_f32 v[56:57], v[42:43], v[56:57], v[60:61] op_sel:[0,0,0] op_sel_hi:[0,1,1]
    v_pk_fma_f32 v[58:59], v[42:43], v[58:59], v[62:63] op_sel:[0,0,0] op_sel_hi:[0,1,1]
    v_pk_fma_f32 v[60:61], v[42:43], v[58:59], v[134:135] op_sel:[1,0,0] op_sel_hi:[1,1,1] neg_lo:[1,0,0] neg_hi:[1,0,0]
    v_pk_fma_f32 v[62:63], v[42:43], v[56:57], v[150:151] op_sel:[1,0,0] op_sel_hi:[1,1,1]
    v_pk_fma_f32 v[56:57], v[42:43], v[56:57], v[60:61] op_sel:[0,0,0] op_sel_hi:[0,1,1]
    v_pk_fma_f32 v[58:59], v[42:43], v[58:59], v[62:63] op_sel:[0,0,0] op_sel_hi:[0,1,1]
    v_pk_fma_f32 v[60:61], v[42:43], v[58:59], v[136:137] op_sel:[1,0,0] op_sel_hi:[1,1,1] neg_lo:[1,0,0] neg_hi:[1,0,0]
    v_pk_fma_f32 v[62:63], v[42:43], v[56:57], v[152:153] op_sel:[1,0,0] op_sel_hi:[1,1,1]
    v_pk_fma_f32 v[56:57], v[42:43], v[56:57], v[60:61] op_sel:[0,0,0] op_sel_hi:[0,1,1]
    v_pk_fma_f32 v[58:59], v[42:43], v[58:59], v[62:63] op_sel:[0,0,0] op_sel_hi:[0,1,1]
    v_pk_fma_f32 v[60:61], v[42:43], v[58:59], v[138:139] op_sel:[1,0,0] op_sel_hi:[1,1,1] neg_lo:[1,0,0] neg_hi:[1,0,0]
    v_pk_fma_f32 v[62:63], v[42:43], v[56:57], v[154:155] op_sel:[1,0,0] op_sel_hi:[1,1,1]
    v_pk_fma_f32 v[56:57], v[42:43], v[56:57], v[60:61] op_sel:[0,0,0] op_sel_hi:[0,1,1]
    v_pk_fma_f32 v[58:59], v[42:43], v[58:59], v[62:63] op_sel:[0,0,0] op_sel_hi:[0,1,1]
    v_pk_fma_f32 v[60:61], v[42:43], v[58:59], v[140:141] op_sel:[1,0,0] op_sel_hi:[1,1,1] neg_lo:[1,0,0] neg_hi:[1,0,0]
    v_pk_fma_f32 v[62:63], v[42:43], v[56:57], v[156:157] op_sel:[1,0,0] op_sel_hi:[1,1,1]
    v_pk_fma_f32 v[56:57], v[42:43], v[56:57], v[60:61] op_sel:[0,0,0] op_sel_hi:[0,1,1]
    v_pk_fma_f32 v[58:59], v[42:43], v[58:59], v[62:63] op_sel:[0,0,0] op_sel_hi:[0,1,1]
    v_pk_fma_f32 v[60:61], v[42:43], v[58:59], v[142:143] op_sel:[1,0,0] op_sel_hi:[1,1,1] neg_lo:[1,0,0] neg_hi:[1,0,0]
    v_pk_fma_f32 v[62:63], v[42:43], v[56:57], v[158:159] op_sel:[1,0,0] op_sel_hi:[1,1,1]
    v_pk_fma_f32 v[56:57], v[42:43], v[56:57], v[60:61] op_sel:[0,0,0] op_sel_hi:[0,1,1]
    v_pk_fma_f32 v[58:59], v[42:43], v[58:59], v[62:63] op_sel:[0,0,0] op_sel_hi:[0,1,1]
    v_pk_fma_f32 v[60:61], v[42:43], v[58:59], v[160:161] op_sel:[1,0,0] op_sel_hi:[1,1,1] neg_lo:[1,0,0] neg_hi:[1,0,0]
    v_pk_fma_f32 v[62:63], v[42:43], v[56:57], v[176:177] op_sel:[1,0,0] op_sel_hi:[1,1,1]
    v_pk_fma_f32 v[56:57], v[42:43], v[56:57], v[60:61] op_sel:[0,0,0] op_sel_hi:[0,1,1]
    v_pk_fma_f32 v[58:59], v[42:43], v[58:59], v[62:63] op_sel:[0,0,0] op_sel_hi:[0,1,1]
    v_pk_fma_f32 v[60:61], v[42:43], v[58:59], v[162:163] op_sel:[1,0,0] op_sel_hi:[1,1,1] neg_lo:[1,0,0] neg_hi:[1,0,0]
    v_pk_fma_f32 v[62:63], v[42:43], v[56:57], v[178:179] op_sel:[1,0,0] op_sel_hi:[1,1,1]
    v_pk_fma_f32 v[56:57], v[42:43], v[56:57], v[60:61] op_sel:[0,0,0] op_sel_hi:[0,1,1]
    v_pk_fma_f32 v[58:59], v[42:43], v[58:59], v[62:63] op_sel:[0,0,0] op_sel_hi:[0,1,1]
    v_pk_fma_f32 v[60:61], v[42:43], v[58:59], v[164:165] op_sel:[1,0,0] op_sel_hi:[1,1,1] neg_lo:[1,0,0] neg_hi:[1,0,0]
    v_pk_fma_f32 v[62:63], v[42:43], v[56:57], v[180:181] op_sel:[1,0,0] op_sel_hi:[1,1,1]
    v_pk_fma_f32 v[56:57], v[42:43], v[56:57], v[60:61] op_sel:[0,0,0] op_sel_hi:[0,1,1]
    v_pk_fma_f32 v[58:59], v[42:43], v[58:59], v[62:63] op_sel:[0,0,0] op_sel_hi:[0,1,1]
    v_pk_fma_f32 v[60:61], v[42:43], v[58:59], v[166:167] op_sel:[1,0,0] op_sel_hi:[1,1,1] neg_lo:[1,0,0] neg_hi:[1,0,0]
    v_pk_fma_f32 v[62:63], v[42:43], v[56:57], v[182:183] op_sel:[1,0,0] op_sel_hi:[1,1,1]
    v_pk_fma_f32 v[56:57], v[42:43], v[56:57], v[60:61] op_sel:[0,0,0] op_sel_hi:[0,1,1]
    v_pk_fma_f32 v[58:59], v[42:43], v[58:59], v[62:63] op_sel:[0,0,0] op_sel_hi:[0,1,1]
    v_pk_fma_f32 v[60:61], v[42:43], v[58:59], v[168:169] op_sel:[1,0,0] op_sel_hi:[1,1,1] neg_lo:[1,0,0] neg_hi:[1,0,0]
    v_pk_fma_f32 v[62:63], v[42:43], v[56:57], v[184:185] op_sel:[1,0,0] op_sel_hi:[1,1,1]
    v_pk_fma_f32 v[56:57], v[42:43], v[56:57], v[60:61] op_sel:[0,0,0] op_sel_hi:[0,1,1]
    v_pk_fma_f32 v[58:59], v[42:43], v[58:59], v[62:63] op_sel:[0,0,0] op_sel_hi:[0,1,1]
    v_pk_fma_f32 v[60:61], v[42:43], v[58:59], v[170:171] op_sel:[1,0,0] op_sel_hi:[1,1,1] neg_lo:[1,0,0] neg_hi:[1,0,0]
    v_pk_fma_f32 v[62:63], v[42:43], v[56:57], v[186:187] op_sel:[1,0,0] op_sel_hi:[1,1,1]
    v_pk_fma_f32 v[56:57], v[42:43], v[56:57], v[60:61] op_sel:[0,0,0] op_sel_hi:[0,1,1]
    v_pk_fma_f32 v[58:59], v[42:43], v[58:59], v[62:63] op_sel:[0,0,0] op_sel_hi:[0,1,1]
    v_pk_fma_f32 v[60:61], v[42:43], v[58:59], v[172:173] op_sel:[1,0,0] op_sel_hi:[1,1,1] neg_lo:[1,0,0] neg_hi:[1,0,0]
    v_pk_fma_f32 v[62:63], v[42:43], v[56:57], v[188:189] op_sel:[1,0,0] op_sel_hi:[1,1,1]
    v_pk_fma_f32 v[56:57], v[42:43], v[56:57], v[60:61] op_sel:[0,0,0] op_sel_hi:[0,1,1]
    v_pk_fma_f32 v[58:59], v[42:43], v[58:59], v[62:63] op_sel:[0,0,0] op_sel_hi:[0,1,1]
    v_pk_fma_f32 v[60:61], v[42:43], v[58:59], v[174:175] op_sel:[1,0,0] op_sel_hi:[1,1,1] neg_lo:[1,0,0] neg_hi:[1,0,0]
    v_pk_fma_f32 v[62:63], v[42:43], v[56:57], v[190:191] op_sel:[1,0,0] op_sel_hi:[1,1,1]
    v_pk_fma_f32 v[56:57], v[42:43], v[56:57], v[60:61] op_sel:[0,0,0] op_sel_hi:[0,1,1]
    v_pk_fma_f32 v[58:59], v[42:43], v[58:59], v[62:63] op_sel:[0,0,0] op_sel_hi:[0,1,1]
    v_and_b32 v2, 31, v1
    s_lshl_b32 s41, s40, 5
    v_add_u32 v2, s41, v2
    v_lshlrev_b32 v9, 4, v2
    v_lshlrev_b32 v2, 3, v2
    v_add_u32 v2, 32768, v2
    v_lshrrev_b32 v3, 5, v1
    v_lshl_add_u32 v3, v3, 10, v2
    s_lshl_b32 s41, s39, 11
    v_add_u32 v3, s41, v3
    ds_write2_b32 v3, v56, v58 offset0:0 offset1:1
    ds_write2_b32 v3, v57, v59 offset0:128 offset1:129
    v_mov_b32 v7, 36864
    s_cmp_lg_u32 s38, 0
    s_cbranch_scc1 L_ssm_no_nonce2
    s_mov_b32 s43, 0
L_nw_ssm:
    s_waitcnt vmcnt(0)
    v_readfirstlane_b32 s47, v252
    s_nop 3
    s_cmp_lg_u32 s47, 0
    s_cbranch_scc1 L_nw_done_ssm
    s_add_u32 s43, s43, 1
    s_cmp_lt_u32 s43, 0x100000
    s_cbranch_scc0 L_nw_done_ssm
    v_mov_b32 v253, 0
    global_load_dword v252, v253, s[32:33] sc0 sc1
    s_branch L_nw_ssm
L_nw_done_ssm:
    s_mov_b64 exec, 1
    ds_write_b32 v7, v252
    s_mov_b64 exec, -1
L_ssm_no_nonce2:
    s_waitcnt lgkmcnt(0)
    s_barrier
    ds_read_b32 v8, v7
    ds_read_b64 v[64:65], v2 offset:0
    ds_read_b64 v[66:67], v2 offset:512
    ds_read_b64 v[68:69], v2 offset:1024
    ds_read_b64 v[70:71], v2 offset:1536
    ds_read_b64 v[72:73], v2 offset:2048
    ds_read_b64 v[74:75], v2 offset:2560
    ds_read_b64 v[76:77], v2 offset:3072
    ds_read_b64 v[78:79], v2 offset:3584
    s_lshl_b32 s41, s37, 14
    s_add_u32 s41, s41, 15147008
    s_add_u32 s64, s34, s41
    s_addc_u32 s65, s35, 0
    s_mov_b32 s66, 16384
    s_mov_b32 s67, 0x20000
    v_lshrrev_b32 v4, 5, v1
    s_sub_u32 s42, s36, 1
    v_sub_u32 v4, s42, v4
    v_lshl_add_u32 v5, v4, 10, v9
    v_subrev_u32 v10, 0, v5
    v_subrev_u32 v11, 2048, v5
    v_subrev_u32 v12, 4096, v5
    v_subrev_u32 v13, 6144, v5
    v_subrev_u32 v14, 8192, v5
    v_subrev_u32 v15, 10240, v5
    v_subrev_u32 v16, 12288, v5
    v_subrev_u32 v17, 14336, v5
    s_lshl_b32 s41, s37, 4
    s_add_u32 s41, s41, s36
    s_lshl_b32 s41, s41, 10
    s_add_u32 s41, s41, 15147008
    s_waitcnt lgkmcnt(0)
    v_mov_b32 v80, v64
    v_mov_b32 v81, v65
    v_pk_fma_f32 v[60:61], v[44:45], v[80:81], v[66:67] op_sel:[0,0,0] op_sel_hi:[0,1,1]
    v_pk_fma_f32 v[82:83], v[44:45], v[80:81], v[60:61] op_sel:[1,1,0] op_sel_hi:[1,0,1] neg_lo:[1,0,0]
    v_pk_fma_f32 v[60:61], v[44:45], v[82:83], v[68:69] op_sel:[0,0,0] op_sel_hi:[0,1,1]
    v_pk_fma_f32 v[84:85], v[44:45], v[82:83], v[60:61] op_sel:[1,1,0] op_sel_hi:[1,0,1] neg_lo:[1,0,0]
    v_pk_fma_f32 v[60:61], v[44:45], v[84:85], v[70:71] op_sel:[0,0,0] op_sel_hi:[0,1,1]
    v_pk_fma_f32 v[86:87], v[44:45], v[84:85], v[60:61] op_sel:[1,1,0] op_sel_hi:[1,0,1] neg_lo:[1,0,0]
    v_pk_fma_f32 v[60:61], v[44:45], v[86:87], v[72:73] op_sel:[0,0,0] op_sel_hi:[0,1,1]
    v_pk_fma_f32 v[88:89], v[44:45], v[86:87], v[60:61] op_sel:[1,1,0] op_sel_hi:[1,0,1] neg_lo:[1,0,0]
    v_pk_fma_f32 v[60:61], v[44:45], v[88:89], v[74:75] op_sel:[0,0,0] op_sel_hi:[0,1,1]
    v_pk_fma_f32 v[90:91], v[44:45], v[88:89], v[60:61] op_sel:[1,1,0] op_sel_hi:[1,0,1] neg_lo:[1,0,0]
    v_pk_fma_f32 v[60:61], v[44:45], v[90:91], v[76:77] op_sel:[0,0,0] op_sel_hi:[0,1,1]
    v_pk_fma_f32 v[92:93], v[44:45], v[90:91], v[60:61] op_sel:[1,1,0] op_sel_hi:[1,0,1] neg_lo:[1,0,0]
    v_pk_fma_f32 v[60:61], v[44:45], v[92:93], v[78:79] op_sel:[0,0,0] op_sel_hi:[0,1,1]
    v_pk_fma_f32 v[94:95], v[44:45], v[92:93], v[60:61] op_sel:[1,1,0] op_sel_hi:[1,0,1] neg_lo:[1,0,0]
    v_mov_b32 v20, v94
    v_mov_b32 v21, v8
    v_mov_b32 v22, v95
    v_mov_b32 v23, v8
    s_cmp_lg_u32 s39, 0
    s_cbranch_scc1 L_ssm_no_pub
    s_mov_b32 exec_hi, 0
    buffer_store_dwordx4 v[20:23], v9, s[56:59], s41 offen sc0 sc1
    s_mov_b64 exec, -1
L_ssm_no_pub:
    v_readfirstlane_b32 s47, v8
    v_mov_b32 v9, v4
    v_lshrrev_b32 v4, 5, v1
    v_lshlrev_b32 v4, 4, v4
    v_bfe_u32 v5, v1, 4, 1
    v_lshl_add_u32 v4, v5, 2, v4
    v_bfe_u32 v5, v1, 2, 2
    v_add_u32 v4, v4, v5
    v_lshlrev_b32 v4, 6, v4
    v_and_b32 v5, 3, v1
    v_lshl_add_u32 v4, v5, 3, v4
    v_add_u32 v40, s93, v4
    v_and_b32 v5, 15, v1
    v_lshlrev_b32 v5, 6, v5
    v_lshrrev_b32 v6, 4, v1
    v_lshl_add_u32 v5, v6, 3, v5
    v_add_u32 v41, s93, v5
    s_mov_b32 s6, 0x05040100
    s_mov_b32 s7, 0x07060302
    s_waitcnt vmcnt(10)
    ds_read_b64_tr_b16 v[96:97], v40 offset:0
    ds_read_b64_tr_b16 v[98:99], v40 offset:512
    ds_read_b64_tr_b16 v[100:101], v40 offset:32
    ds_read_b64_tr_b16 v[102:103], v40 offset:544
    ds_read_b64 v[24:25], v41 offset:2048
    ds_read_b64 v[26:27], v41 offset:3072
    ds_read_b64 v[28:29], v41 offset:2080
    ds_read_b64 v[30:31], v41 offset:3104
    ds_read_b64_tr_b16 v[104:105], v40 offset:4096
    ds_read_b64_tr_b16 v[106:107], v40 offset:4608
    ds_read_b64_tr_b16 v[108:109], v40 offset:4128
    ds_read_b64_tr_b16 v[110:111], v40 offset:4640
    ds_read_b64 v[32:33], v41 offset:6144
    ds_read_b64 v[34:35], v41 offset:7168
    ds_read_b64 v[36:37], v41 offset:6176
    ds_read_b64 v[38:39], v41 offset:7200
    v_cmp_lt_u32 vcc, 31, v1
    v_mov_b32 v60, 0
    s_nop 0
    v_cndmask_b32 v62, v60, v82, vcc
    v_cndmask_b32 v63, v86, v90, vcc
    v_cndmask_b32 v64, v62, v63, s[94:95]
    v_cndmask_b32 v62, v80, v84, vcc
    v_cndmask_b32 v63, v88, v92, vcc
    v_cndmask_b32 v66, v62, v63, s[94:95]
    v_cndmask_b32 v62, v60, v83, vcc
    v_cndmask_b32 v63, v87, v91, vcc
    v_cndmask_b32 v65, v62, v63, s[94:95]
    v_cndmask_b32 v62, v81, v85, vcc
    v_cndmask_b32 v63, v89, v93, vcc
    v_cndmask_b32 v67, v62, v63, s[94:95]
    v_mul_f32 v68, v50, v64
    v_mul_f32 v70, v50, v65
    v_fma_f32 v68, -v51, v65, v68
    v_fma_f32 v70, v51, v64, v70
    v_mul_f32 v72, v50, v52
    v_mul_f32 v74, v50, v54
    v_fma_f32 v72, -v51, v54, v72
    v_fma_f32 v74, v51, v52, v74
    v_mul_f32 v69, v50, v66
    v_mul_f32 v71, v50, v67
    v_fma_f32 v69, -v51, v67, v69
    v_fma_f32 v71, v51, v66, v71
    v_mul_f32 v73, v50, v53
    v_mul_f32 v75, v50, v55
    v_fma_f32 v73, -v51, v55, v73
    v_fma_f32 v75, v51, v53, v75
    s_waitcnt lgkmcnt(0)
    buffer_store_dwordx4 v[96:99], v248, s[56:59], s76 offen sc1
    buffer_store_dwordx4 v[100:103], v248, s[56:59], s77 offen sc1
    v_perm_b32 v112, v26, v24, s6
    v_perm_b32 v113, v26, v24, s7
    v_perm_b32 v114, v27, v25, s6
    v_perm_b32 v115, v27, v25, s7
    buffer_store_dwordx4 v[112:115], v248, s[56:59], s82 offen sc1
    v_perm_b32 v116, v30, v28, s6
    v_perm_b32 v117, v30, v28, s7
    v_perm_b32 v118, v31, v29, s6
    v_perm_b32 v119, v31, v29, s7
    buffer_store_dwordx4 v[116:119], v248, s[56:59], s83 offen sc1
    buffer_store_dwordx4 v[104:107], v248, s[56:59], s78 offen sc1
    buffer_store_dwordx4 v[108:111], v248, s[56:59], s79 offen sc1
    v_perm_b32 v112, v34, v32, s6
    v_perm_b32 v113, v34, v32, s7
    v_perm_b32 v114, v35, v33, s6
    v_perm_b32 v115, v35, v33, s7
    buffer_store_dwordx4 v[112:115], v248, s[56:59], s88 offen sc1
    v_perm_b32 v116, v38, v36, s6
    v_perm_b32 v117, v38, v36, s7
    v_perm_b32 v118, v39, v37, s6
    v_perm_b32 v119, v39, v37, s7
    buffer_store_dwordx4 v[116:119], v248, s[56:59], s89 offen sc1
    v_pk_mul_f32 v[60:61], v[50:51], v[144:145] op_sel:[1,0] op_sel_hi:[1,1]
    v_pk_mul_f32 v[62:63], v[50:51], v[128:129] op_sel:[1,0] op_sel_hi:[1,1]
    v_pk_fma_f32 v[128:129], v[50:51], v[128:129], v[60:61] op_sel:[0,0,0] op_sel_hi:[0,1,1] neg_lo:[0,0,1] neg_hi:[0,0,1]
    v_pk_fma_f32 v[144:145], v[50:51], v[144:145], v[62:63] op_sel:[0,0,0] op_sel_hi:[0,1,1]
    v_pk_mul_f32 v[60:61], v[50:51], v[146:147] op_sel:[1,0] op_sel_hi:[1,1]
    v_pk_mul_f32 v[62:63], v[50:51], v[130:131] op_sel:[1,0] op_sel_hi:[1,1]
    v_pk_fma_f32 v[130:131], v[50:51], v[130:131], v[60:61] op_sel:[0,0,0] op_sel_hi:[0,1,1] neg_lo:[0,0,1] neg_hi:[0,0,1]
    v_pk_fma_f32 v[146:147], v[50:51], v[146:147], v[62:63] op_sel:[0,0,0] op_sel_hi:[0,1,1]
    v_pk_mul_f32 v[60:61], v[50:51], v[148:149] op_sel:[1,0] op_sel_hi:[1,1]
    v_pk_mul_f32 v[62:63], v[50:51], v[132:133] op_sel:[1,0] op_sel_hi:[1,1]
    v_pk_fma_f32 v[132:133], v[50:51], v[132:133], v[60:61] op_sel:[0,0,0] op_sel_hi:[0,1,1] neg_lo:[0,0,1] neg_hi:[0,0,1]
    v_pk_fma_f32 v[148:149], v[50:51], v[148:149], v[62:63] op_sel:[0,0,0] op_sel_hi:[0,1,1]
    v_pk_mul_f32 v[60:61], v[50:51], v[150:151] op_sel:[1,0] op_sel_hi:[1,1]
    v_pk_mul_f32 v[62:63], v[50:51], v[134:135] op_sel:[1,0] op_sel_hi:[1,1]
    v_pk_fma_f32 v[134:135], v[50:51], v[134:135], v[60:61] op_sel:[0,0,0] op_sel_hi:[0,1,1] neg_lo:[0,0,1] neg_hi:[0,0,1]
    v_pk_fma_f32 v[150:151], v[50:51], v[150:151], v[62:63] op_sel:[0,0,0] op_sel_hi:[0,1,1]
    v_pk_mul_f32 v[60:61], v[50:51], v[152:153] op_sel:[1,0] op_sel_hi:[1,1]
    v_pk_mul_f32 v[62:63], v[50:51], v[136:137] op_sel:[1,0] op_sel_hi:[1,1]
    v_pk_fma_f32 v[136:137], v[50:51], v[136:137], v[60:61] op_sel:[0,0,0] op_sel_hi:[0,1,1] neg_lo:[0,0,1] neg_hi:[0,0,1]
    v_pk_fma_f32 v[152:153], v[50:51], v[152:153], v[62:63] op_sel:[0,0,0] op_sel_hi:[0,1,1]
    v_pk_mul_f32 v[60:61], v[50:51], v[154:155] op_sel:[1,0] op_sel_hi:[1,1]
    v_pk_mul_f32 v[62:63], v[50:51], v[138:139] op_sel:[1,0] op_sel_hi:[1,1]
    v_pk_fma_f32 v[138:139], v[50:51], v[138:139], v[60:61] op_sel:[0,0,0] op_sel_hi:[0,1,1] neg_lo:[0,0,1] neg_hi:[0,0,1]
    v_pk_fma_f32 v[154:155], v[50:51], v[154:155], v[62:63] op_sel:[0,0,0] op_sel_hi:[0,1,1]
    v_pk_mul_f32 v[60:61], v[50:51], v[156:157] op_sel:[1,0] op_sel_hi:[1,1]
    v_pk_mul_f32 v[62:63], v[50:51], v[140:141] op_sel:[1,0] op_sel_hi:[1,1]
    v_pk_fma_f32 v[140:141], v[50:51], v[140:141], v[60:61] op_sel:[0,0,0] op_sel_hi:[0,1,1] neg_lo:[0,0,1] neg_hi:[0,0,1]
    v_pk_fma_f32 v[156:157], v[50:51], v[156:157], v[62:63] op_sel:[0,0,0] op_sel_hi:[0,1,1]
    v_pk_mul_f32 v[60:61], v[50:51], v[158:159] op_sel:[1,0] op_sel_hi:[1,1]
    v_pk_mul_f32 v[62:63], v[50:51], v[142:143] op_sel:[1,0] op_sel_hi:[1,1]
    v_pk_fma_f32 v[142:143], v[50:51], v[142:143], v[60:61] op_sel:[0,0,0] op_sel_hi:[0,1,1] neg_lo:[0,0,1] neg_hi:[0,0,1]
    v_pk_fma_f32 v[158:159], v[50:51], v[158:159], v[62:63] op_sel:[0,0,0] op_sel_hi:[0,1,1]
    v_pk_mul_f32 v[60:61], v[50:51], v[176:177] op_sel:[1,0] op_sel_hi:[1,1]
    v_pk_mul_f32 v[62:63], v[50:51], v[160:161] op_sel:[1,0] op_sel_hi:[1,1]
    v_pk_fma_f32 v[160:161], v[50:51], v[160:161], v[60:61] op_sel:[0,0,0] op_sel_hi:[0,1,1] neg_lo:[0,0,1] neg_hi:[0,0,1]
    v_pk_fma_f32 v[176:177], v[50:51], v[176:177], v[62:63] op_sel:[0,0,0] op_sel_hi:[0,1,1]
    v_pk_mul_f32 v[60:61], v[50:51], v[178:179] op_sel:[1,0] op_sel_hi:[1,1]
    v_pk_mul_f32 v[62:63], v[50:51], v[162:163] op_sel:[1,0] op_sel_hi:[1,1]
    v_pk_fma_f32 v[162:163], v[50:51], v[162:163], v[60:61] op_sel:[0,0,0] op_sel_hi:[0,1,1] neg_lo:[0,0,1] neg_hi:[0,0,1]
    v_pk_fma_f32 v[178:179], v[50:51], v[178:179], v[62:63] op_sel:[0,0,0] op_sel_hi:[0,1,1]
    v_pk_mul_f32 v[60:61], v[50:51], v[180:181] op_sel:[1,0] op_sel_hi:[1,1]
    v_pk_mul_f32 v[62:63], v[50:51], v[164:165] op_sel:[1,0] op_sel_hi:[1,1]
    v_pk_fma_f32 v[164:165], v[50:51], v[164:165], v[60:61] op_sel:[0,0,0] op_sel_hi:[0,1,1] neg_lo:[0,0,1] neg_hi:[0,0,1]
    v_pk_fma_f32 v[180:181], v[50:51], v[180:181], v[62:63] op_sel:[0,0,0] op_sel_hi:[0,1,1]
    v_pk_mul_f32 v[60:61], v[50:51], v[182:183] op_sel:[1,0] op_sel_hi:[1,1]
    v_pk_mul_f32 v[62:63], v[50:51], v[166:167] op_sel:[1,0] op_sel_hi:[1,1]
    v_pk_fma_f32 v[166:167], v[50:51], v[166:167], v[60:61] op_sel:[0,0,0] op_sel_hi:[0,1,1] neg_lo:[0,0,1] neg_hi:[0,0,1]
    v_pk_fma_f32 v[182:183], v[50:51], v[182:183], v[62:63] op_sel:[0,0,0] op_sel_hi:[0,1,1]
    v_pk_mul_f32 v[60:61], v[50:51], v[184:185] op_sel:[1,0] op_sel_hi:[1,1]
    v_pk_mul_f32 v[62:63], v[50:51], v[168:169] op_sel:[1,0] op_sel_hi:[1,1]
    v_pk_fma_f32 v[168:169], v[50:51], v[168:169], v[60:61] op_sel:[0,0,0] op_sel_hi:[0,1,1] neg_lo:[0,0,1] neg_hi:[0,0,1]
    v_pk_fma_f32 v[184:185], v[50:51], v[184:185], v[62:63] op_sel:[0,0,0] op_sel_hi:[0,1,1]
    v_pk_mul_f32 v[60:61], v[50:51], v[186:187] op_sel:[1,0] op_sel_hi:[1,1]
    v_pk_mul_f32 v[62:63], v[50:51], v[170:171] op_sel:[1,0] op_sel_hi:[1,1]
    v_pk_fma_f32 v[170:171], v[50:51], v[170:171], v[60:61] op_sel:[0,0,0] op_sel_hi:[0,1,1] neg_lo:[0,0,1] neg_hi:[0,0,1]
    v_pk_fma_f32 v[186:187], v[50:51], v[186:187], v[62:63] op_sel:[0,0,0] op_sel_hi:[0,1,1]
    v_pk_mul_f32 v[60:61], v[50:51], v[188:189] op_sel:[1,0] op_sel_hi:[1,1]
    v_pk_mul_f32 v[62:63], v[50:51], v[172:173] op_sel:[1,0] op_sel_hi:[1,1]
    v_pk_fma_f32 v[172:173], v[50:51], v[172:173], v[60:61] op_sel:[0,0,0] op_sel_hi:[0,1,1] neg_lo:[0,0,1] neg_hi:[0,0,1]
    v_pk_fma_f32 v[188:189], v[50:51], v[188:189], v[62:63] op_sel:[0,0,0] op_sel_hi:[0,1,1]
    v_pk_mul_f32 v[60:61], v[50:51], v[190:191] op_sel:[1,0] op_sel_hi:[1,1]
    v_pk_mul_f32 v[62:63], v[50:51], v[174:175] op_sel:[1,0] op_sel_hi:[1,1]
    v_pk_fma_f32 v[174:175], v[50:51], v[174:175], v[60:61] op_sel:[0,0,0] op_sel_hi:[0,1,1] neg_lo:[0,0,1] neg_hi:[0,0,1]
    v_pk_fma_f32 v[190:191], v[50:51], v[190:191], v[62:63] op_sel:[0,0,0] op_sel_hi:[0,1,1]
    s_waitcnt vmcnt(0)
    s_barrier
    s_cmp_lg_u32 s38, 0
    s_cbranch_scc1 L_ssm_no_wf
    v_mov_b32 v6, s99
    v_mov_b32 v7, s47
    s_mov_b64 exec, 1
    buffer_store_dword v7, v6, s[56:59], 0 offen sc0 sc1
    s_mov_b64 exec, -1
L_ssm_no_wf:
    buffer_load_dwordx4 v[96:99], v10, s[64:67], 0 offen sc0 sc1
    buffer_load_dwordx4 v[100:103], v11, s[64:67], 0 offen sc0 sc1
    buffer_load_dwordx4 v[104:107], v12, s[64:67], 0 offen sc0 sc1
    buffer_load_dwordx4 v[108:111], v13, s[64:67], 0 offen sc0 sc1
    buffer_load_dwordx4 v[112:115], v14, s[64:67], 0 offen sc0 sc1
    buffer_load_dwordx4 v[116:119], v15, s[64:67], 0 offen sc0 sc1
    buffer_load_dwordx4 v[120:123], v16, s[64:67], 0 offen sc0 sc1
    buffer_load_dwordx4 v[124:127], v17, s[64:67], 0 offen sc0 sc1
    s_mov_b32 s92, 0xffff0000
    s_mov_b32 s41, 0x3f803f80
    s_mov_b32 s42, 0x0000ffff
    v_mov_b32 v26, 0
    v_mov_b32 v27, 0
    v_mov_b32 v28, 0
    v_mov_b32 v29, 0
    v_mov_b32 v30, 0
    v_and_b32 v18, s42, v228
    v_and_b32 v19, s92, v228
    v_and_b32 v20, s42, v229
    v_and_b32 v21, s92, v229
    v_dot2_f32_bf16 v22, v208, v18, 0
    v_dot2_f32_bf16 v23, v208, v19, 0
    v_dot2_f32_bf16 v24, v209, v20, 0
    v_dot2_f32_bf16 v25, v209, v21, 0
    s_nop 1
    v_cvt_pk_bf16_f32 v18, v22, v23
    v_cvt_pk_bf16_f32 v19, v24, v25
    v_dot2_f32_bf16 v26, v18, s41, v26
    v_dot2_f32_bf16 v26, v19, s41, v26
    v_and_b32 v18, s42, v230
    v_and_b32 v19, s92, v230
    v_and_b32 v20, s42, v231
    v_and_b32 v21, s92, v231
    v_dot2_f32_bf16 v22, v210, v18, 0
    v_dot2_f32_bf16 v23, v210, v19, 0
    v_dot2_f32_bf16 v24, v211, v20, 0
    v_dot2_f32_bf16 v25, v211, v21, 0
    s_nop 1
    v_cvt_pk_bf16_f32 v18, v22, v23
    v_cvt_pk_bf16_f32 v19, v24, v25
    v_dot2_f32_bf16 v26, v18, s41, v26
    v_dot2_f32_bf16 v26, v19, s41, v26
    v_and_b32 v18, s42, v232
    v_and_b32 v19, s92, v232
    v_and_b32 v20, s42, v233
    v_and_b32 v21, s92, v233
    v_dot2_f32_bf16 v22, v212, v18, 0
    v_dot2_f32_bf16 v23, v212, v19, 0
    v_dot2_f32_bf16 v24, v213, v20, 0
    v_dot2_f32_bf16 v25, v213, v21, 0
    s_nop 1
    v_cvt_pk_bf16_f32 v18, v22, v23
    v_cvt_pk_bf16_f32 v19, v24, v25
    v_dot2_f32_bf16 v27, v18, s41, v27
    v_dot2_f32_bf16 v27, v19, s41, v27
    v_and_b32 v18, s42, v234
    v_and_b32 v19, s92, v234
    v_and_b32 v20, s42, v235
    v_and_b32 v21, s92, v235
    v_dot2_f32_bf16 v22, v214, v18, 0
    v_dot2_f32_bf16 v23, v214, v19, 0
    v_dot2_f32_bf16 v24, v215, v20, 0
    v_dot2_f32_bf16 v25, v215, v21, 0
    s_nop 1
    v_cvt_pk_bf16_f32 v18, v22, v23
    v_cvt_pk_bf16_f32 v19, v24, v25
    v_dot2_f32_bf16 v27, v18, s41, v27
    v_dot2_f32_bf16 v27, v19, s41, v27
    v_and_b32 v18, s42, v236
    v_and_b32 v19, s92, v236
    v_and_b32 v20, s42, v237
    v_and_b32 v21, s92, v237
    v_dot2_f32_bf16 v22, v216, v18, 0
    v_dot2_f32_bf16 v23, v216, v19, 0
    v_dot2_f32_bf16 v24, v217, v20, 0
    v_dot2_f32_bf16 v25, v217, v21, 0
    s_nop 1
    v_cvt_pk_bf16_f32 v18, v22, v23
    v_cvt_pk_bf16_f32 v19, v24, v25
    v_dot2_f32_bf16 v28, v18, s41, v28
    v_dot2_f32_bf16 v28, v19, s41, v28
    v_and_b32 v18, s42, v238
    v_and_b32 v19, s92, v238
    v_and_b32 v20, s42, v239
    v_and_b32 v21, s92, v239
    v_dot2_f32_bf16 v22, v218, v18, 0
    v_dot2_f32_bf16 v23, v218, v19, 0
    v_dot2_f32_bf16 v24, v219, v20, 0
    v_dot2_f32_bf16 v25, v219, v21, 0
    s_nop 1
    v_cvt_pk_bf16_f32 v18, v22, v23
    v_cvt_pk_bf16_f32 v19, v24, v25
    v_dot2_f32_bf16 v28, v18, s41, v28
    v_dot2_f32_bf16 v28, v19, s41, v28
    v_and_b32 v18, s42, v240
    v_and_b32 v19, s92, v240
    v_and_b32 v20, s42, v241
    v_and_b32 v21, s92, v241
    v_dot2_f32_bf16 v22, v220, v18, 0
    v_dot2_f32_bf16 v23, v220, v19, 0
    v_dot2_f32_bf16 v24, v221, v20, 0
    v_dot2_f32_bf16 v25, v221, v21, 0
    s_nop 1
    v_cvt_pk_bf16_f32 v18, v22, v23
    v_cvt_pk_bf16_f32 v19, v24, v25
    v_dot2_f32_bf16 v29, v18, s41, v29
    v_dot2_f32_bf16 v29, v19, s41, v29
    v_and_b32 v18, s42, v242
    v_and_b32 v19, s92, v242
    v_and_b32 v20, s42, v243
    v_and_b32 v21, s92, v243
    v_dot2_f32_bf16 v22, v222, v18, 0
    v_dot2_f32_bf16 v23, v222, v19, 0
    v_dot2_f32_bf16 v24, v223, v20, 0
    v_dot2_f32_bf16 v25, v223, v21, 0
    s_nop 1
    v_cvt_pk_bf16_f32 v18, v22, v23
    v_cvt_pk_bf16_f32 v19, v24, v25
    v_dot2_f32_bf16 v29, v18, s41, v29
    v_dot2_f32_bf16 v29, v19, s41, v29
    v_and_b32 v18, s42, v244
    v_and_b32 v19, s92, v244
    v_and_b32 v20, s42, v245
    v_and_b32 v21, s92, v245
    v_dot2_f32_bf16 v22, v224, v18, 0
    v_dot2_f32_bf16 v23, v224, v19, 0
    v_dot2_f32_bf16 v24, v225, v20, 0
    v_dot2_f32_bf16 v25, v225, v21, 0
    s_nop 1
    v_cvt_pk_bf16_f32 v18, v22, v23
    v_cvt_pk_bf16_f32 v19, v24, v25
    v_dot2_f32_bf16 v30, v18, s41, v30
    v_dot2_f32_bf16 v30, v19, s41, v30
    v_and_b32 v18, s42, v246
    v_and_b32 v19, s92, v246
    v_and_b32 v20, s42, v247
    v_and_b32 v21, s92, v247
    v_dot2_f32_bf16 v22, v226, v18, 0
    v_dot2_f32_bf16 v23, v226, v19, 0
    v_dot2_f32_bf16 v24, v227, v20, 0
    v_dot2_f32_bf16 v25, v227, v21, 0
    s_nop 1
    v_cvt_pk_bf16_f32 v18, v22, v23
    v_cvt_pk_bf16_f32 v19, v24, v25
    v_dot2_f32_bf16 v30, v18, s41, v30
    v_dot2_f32_bf16 v30, v19, s41, v30
    s_nop 2
    v_cmp_gt_u32 vcc, 16, v1
    v_mov_b32 v18, 0
    s_nop 0
    v_cndmask_b32 v19, v18, v27, vcc
    v_cndmask_b32 v20, v27, v18, vcc
    v_add_f32 v34, v26, v19
    v_mov_b32 v35, v20
    v_cmp_gt_u32 vcc, 32, v1
    v_mov_b32 v18, 0
    s_nop 0
    v_cndmask_b32 v19, v18, v28, vcc
    v_cndmask_b32 v20, v28, v18, vcc
    v_add_f32 v35, v35, v19
    v_mov_b32 v36, v20
    v_cmp_gt_u32 vcc, 48, v1
    v_mov_b32 v18, 0
    s_nop 0
    v_cndmask_b32 v19, v18, v29, vcc
    v_cndmask_b32 v20, v29, v18, vcc
    v_add_f32 v36, v36, v19
    v_mov_b32 v37, v20
    v_add_f32 v37, v37, v30
    v_add_f32_dpp v34, v34, v34 row_ror:1 row_mask:0xf bank_mask:0xf
    v_add_f32_dpp v35, v35, v35 row_ror:1 row_mask:0xf bank_mask:0xf
    v_add_f32_dpp v36, v36, v36 row_ror:1 row_mask:0xf bank_mask:0xf
    v_add_f32_dpp v37, v37, v37 row_ror:1 row_mask:0xf bank_mask:0xf
    v_add_f32_dpp v34, v34, v34 row_ror:2 row_mask:0xf bank_mask:0xf
    v_add_f32_dpp v35, v35, v35 row_ror:2 row_mask:0xf bank_mask:0xf
    v_add_f32_dpp v36, v36, v36 row_ror:2 row_mask:0xf bank_mask:0xf
    v_add_f32_dpp v37, v37, v37 row_ror:2 row_mask:0xf bank_mask:0xf
    v_add_f32_dpp v34, v34, v34 row_ror:4 row_mask:0xf bank_mask:0xf
    v_add_f32_dpp v35, v35, v35 row_ror:4 row_mask:0xf bank_mask:0xf
    v_add_f32_dpp v36, v36, v36 row_ror:4 row_mask:0xf bank_mask:0xf
    v_add_f32_dpp v37, v37, v37 row_ror:4 row_mask:0xf bank_mask:0xf
    v_add_f32_dpp v34, v34, v34 row_ror:8 row_mask:0xf bank_mask:0xf
    v_add_f32_dpp v35, v35, v35 row_ror:8 row_mask:0xf bank_mask:0xf
    v_add_f32_dpp v36, v36, v36 row_ror:8 row_mask:0xf bank_mask:0xf
    v_add_f32_dpp v37, v37, v37 row_ror:8 row_mask:0xf bank_mask:0xf
    v_add_f32_dpp v34, v34, v34 row_bcast:15 row_mask:0xa bank_mask:0xf
    v_add_f32_dpp v35, v35, v35 row_bcast:15 row_mask:0xa bank_mask:0xf
    v_add_f32_dpp v36, v36, v36 row_bcast:15 row_mask:0xa bank_mask:0xf
    v_add_f32_dpp v37, v37, v37 row_bcast:15 row_mask:0xa bank_mask:0xf
    v_add_f32_dpp v34, v34, v34 row_bcast:31 row_mask:0xc bank_mask:0xf
    v_add_f32_dpp v35, v35, v35 row_bcast:31 row_mask:0xc bank_mask:0xf
    v_add_f32_dpp v36, v36, v36 row_bcast:31 row_mask:0xc bank_mask:0xf
    v_add_f32_dpp v37, v37, v37 row_bcast:31 row_mask:0xc bank_mask:0xf
    s_nop 0
    v_readlane_b32 s43, v34, 63
    v_readlane_b32 s44, v35, 63
    v_readlane_b32 s45, v36, 63
    v_readlane_b32 s46, v37, 63
    s_nop 3
    v_writelane_b32 v18, s43, 0
    v_writelane_b32 v18, s44, 1
    v_writelane_b32 v18, s45, 2
    v_writelane_b32 v18, s46, 3
    s_nop 0
    v_cvt_pk_bf16_f32 v18, v18, v18
    v_lshlrev_b32 v18, 16, v18
    v_mul_f32 v18, 0xbfb8aa3b, v18
    v_exp_f32 v18, v18
    s_nop 0
    v_add_f32 v18, 1.0, v18
    v_rcp_f32 v18, v18
    s_nop 0
    v_cvt_pk_bf16_f32 v18, v18, v18
    v_lshlrev_b32 v18, 16, v18
    v_lshlrev_b32 v19, 2, v1
    s_mov_b64 exec, 15
    buffer_store_dword v18, v19, s[56:59], s18 offen sc1
    s_mov_b64 exec, -1
    v_and_b32 v2, 15, v1
    v_lshrrev_b32 v3, 4, v1
    v_lshrrev_b32 v4, 1, v2
    v_xor_b32 v3, v3, v4
    v_lshlrev_b32 v3, 4, v3
    v_lshl_add_u32 v3, v2, 7, v3
    s_lshl_b32 s41, s38, 13
    s_add_u32 s41, s41, 65536
    v_add_u32 v24, s41, v3
    v_xor_b32 v25, 64, v24
    s_lshl_b32 s41, s36, 1
    s_add_u32 s41, s41, s39
    s_mul_i32 s41, s41, 88
    s_lshl_b32 s42, s37, 2
    s_add_u32 s41, s41, s42
    s_lshl_b32 s42, s40, 1
    s_add_u32 s41, s41, s42
    s_lshl_b32 s74, s41, 12
    s_add_u32 s75, s74, 4096
    s_waitcnt vmcnt(1)
    s_mov_b32 s43, 0
    s_branch L_ssm_check
L_ssm_poll:
    buffer_load_dwordx4 v[96:99], v10, s[64:67], 0 offen sc0 sc1
    buffer_load_dwordx4 v[100:103], v11, s[64:67], 0 offen sc0 sc1
    buffer_load_dwordx4 v[104:107], v12, s[64:67], 0 offen sc0 sc1
    buffer_load_dwordx4 v[108:111], v13, s[64:67], 0 offen sc0 sc1
    buffer_load_dwordx4 v[112:115], v14, s[64:67], 0 offen sc0 sc1
    buffer_load_dwordx4 v[116:119], v15, s[64:67], 0 offen sc0 sc1
    buffer_load_dwordx4 v[120:123], v16, s[64:67], 0 offen sc0 sc1
    buffer_load_dwordx4 v[124:127], v17, s[64:67], 0 offen sc0 sc1
    s_waitcnt vmcnt(0)
L_ssm_check:
    s_mov_b64 s[96:97], -1
    v_cmp_eq_u32 vcc, s47, v97
    v_cmp_eq_u32 s[44:45], s47, v99
    s_and_b64 vcc, vcc, s[44:45]
    v_cmp_gt_i32 s[44:45], 0, v9
    s_or_b64 vcc, vcc, s[44:45]
    s_and_b64 s[96:97], s[96:97], vcc
    v_cmp_eq_u32 vcc, s47, v101
    v_cmp_eq_u32 s[44:45], s47, v103
    s_and_b64 vcc, vcc, s[44:45]
    v_cmp_gt_i32 s[44:45], 2, v9
    s_or_b64 vcc, vcc, s[44:45]
    s_and_b64 s[96:97], s[96:97], vcc
    v_cmp_eq_u32 vcc, s47, v105
    v_cmp_eq_u32 s[44:45], s47, v107
    s_and_b64 vcc, vcc, s[44:45]
    v_cmp_gt_i32 s[44:45], 4, v9
    s_or_b64 vcc, vcc, s[44:45]
    s_and_b64 s[96:97], s[96:97], vcc
    v_cmp_eq_u32 vcc, s47, v109
    v_cmp_eq_u32 s[44:45], s47, v111
    s_and_b64 vcc, vcc, s[44:45]
    v_cmp_gt_i32 s[44:45], 6, v9
    s_or_b64 vcc, vcc, s[44:45]
    s_and_b64 s[96:97], s[96:97], vcc
    v_cmp_eq_u32 vcc, s47, v113
    v_cmp_eq_u32 s[44:45], s47, v115
    s_and_b64 vcc, vcc, s[44:45]
    v_cmp_gt_i32 s[44:45], 8, v9
    s_or_b64 vcc, vcc, s[44:45]
    s_and_b64 s[96:97], s[96:97], vcc
    v_cmp_eq_u32 vcc, s47, v117
    v_cmp_eq_u32 s[44:45], s47, v119
    s_and_b64 vcc, vcc, s[44:45]
    v_cmp_gt_i32 s[44:45], 10, v9
    s_or_b64 vcc, vcc, s[44:45]
    s_and_b64 s[96:97], s[96:97], vcc
    v_cmp_eq_u32 vcc, s47, v121
    v_cmp_eq_u32 s[44:45], s47, v123
    s_and_b64 vcc, vcc, s[44:45]
    v_cmp_gt_i32 s[44:45], 12, v9
    s_or_b64 vcc, vcc, s[44:45]
    s_and_b64 s[96:97], s[96:97], vcc
    v_cmp_eq_u32 vcc, s47, v125
    v_cmp_eq_u32 s[44:45], s47, v127
    s_and_b64 vcc, vcc, s[44:45]
    v_cmp_gt_i32 s[44:45], 14, v9
    s_or_b64 vcc, vcc, s[44:45]
    s_and_b64 s[96:97], s[96:97], vcc
    s_cmp_eq_u64 s[96:97], -1
    s_cbranch_scc1 L_ssm_poll_done
    s_add_u32 s43, s43, 1
    s_cmp_lt_u32 s43, 0x100000
    s_cbranch_scc0 L_ssm_poll_done
    s_branch L_ssm_poll
L_ssm_poll_done:
    buffer_load_dword v250, v251, s[56:59], 0 offen sc0 sc1
    v_mov_b32 v56, v124
    v_mov_b32 v57, v126
    v_mov_b32 v62, v120
    v_mov_b32 v63, v122
    v_pk_fma_f32 v[60:61], v[48:49], v[56:57], v[62:63] op_sel:[0,0,0] op_sel_hi:[0,1,1]
    v_pk_fma_f32 v[56:57], v[48:49], v[56:57], v[60:61] op_sel:[1,1,0] op_sel_hi:[1,0,1] neg_lo:[1,0,0]
    v_mov_b32 v62, v116
    v_mov_b32 v63, v118
    v_pk_fma_f32 v[60:61], v[48:49], v[56:57], v[62:63] op_sel:[0,0,0] op_sel_hi:[0,1,1]
    v_pk_fma_f32 v[56:57], v[48:49], v[56:57], v[60:61] op_sel:[1,1,0] op_sel_hi:[1,0,1] neg_lo:[1,0,0]
    v_mov_b32 v62, v112
    v_mov_b32 v63, v114
    v_pk_fma_f32 v[60:61], v[48:49], v[56:57], v[62:63] op_sel:[0,0,0] op_sel_hi:[0,1,1]
    v_pk_fma_f32 v[56:57], v[48:49], v[56:57], v[60:61] op_sel:[1,1,0] op_sel_hi:[1,0,1] neg_lo:[1,0,0]
    v_mov_b32 v62, v108
    v_mov_b32 v63, v110
    v_pk_fma_f32 v[60:61], v[48:49], v[56:57], v[62:63] op_sel:[0,0,0] op_sel_hi:[0,1,1]
    v_pk_fma_f32 v[56:57], v[48:49], v[56:57], v[60:61] op_sel:[1,1,0] op_sel_hi:[1,0,1] neg_lo:[1,0,0]
    v_mov_b32 v62, v104
    v_mov_b32 v63, v106
    v_pk_fma_f32 v[60:61], v[48:49], v[56:57], v[62:63] op_sel:[0,0,0] op_sel_hi:[0,1,1]
    v_pk_fma_f32 v[56:57], v[48:49], v[56:57], v[60:61] op_sel:[1,1,0] op_sel_hi:[1,0,1] neg_lo:[1,0,0]
    v_mov_b32 v62, v100
    v_mov_b32 v63, v102
    v_pk_fma_f32 v[60:61], v[48:49], v[56:57], v[62:63] op_sel:[0,0,0] op_sel_hi:[0,1,1]
    v_pk_fma_f32 v[56:57], v[48:49], v[56:57], v[60:61] op_sel:[1,1,0] op_sel_hi:[1,0,1] neg_lo:[1,0,0]
    v_mov_b32 v62, v96
    v_mov_b32 v63, v98
    v_pk_fma_f32 v[60:61], v[48:49], v[56:57], v[62:63] op_sel:[0,0,0] op_sel_hi:[0,1,1]
    v_pk_fma_f32 v[56:57], v[48:49], v[56:57], v[60:61] op_sel:[1,1,0] op_sel_hi:[1,0,1] neg_lo:[1,0,0]
    v_mul_f32 v60, v46, v56
    v_mul_f32 v61, v46, v57
    v_fma_f32 v60, -v47, v57, v60
    v_fma_f32 v61, v47, v56, v61
    v_cmp_lt_u32 vcc, 31, v1
    s_nop 1
    v_cndmask_b32 v56, v56, v60, vcc
    v_cndmask_b32 v57, v57, v61, vcc
    v_mov_b32 v60, v56
    v_mov_b32 v61, v57
    s_nop 1
    v_permlane32_swap_b32 v56, v60
    v_permlane32_swap_b32 v57, v61
    s_nop 1
    v_add_f32 v56, v56, v60
    v_add_f32 v57, v57, v61
    v_pk_fma_f32 v[60:61], v[72:73], v[56:57], v[68:69] op_sel:[0,0,0] op_sel_hi:[1,0,1]
    v_pk_fma_f32 v[62:63], v[72:73], v[56:57], v[70:71] op_sel:[0,1,0] op_sel_hi:[1,1,1]
    v_pk_fma_f32 v[60:61], v[74:75], v[56:57], v[60:61] op_sel:[0,1,0] op_sel_hi:[1,1,1] neg_lo:[1,0,0] neg_hi:[1,0,0]
    v_pk_fma_f32 v[62:63], v[74:75], v[56:57], v[62:63] op_sel:[0,0,0] op_sel_hi:[1,0,1]
    v_pk_fma_f32 v[128:129], v[42:43], v[62:63], v[128:129] op_sel:[1,0,0] op_sel_hi:[1,1,1] neg_lo:[1,0,0] neg_hi:[1,0,0]
    v_pk_fma_f32 v[144:145], v[42:43], v[60:61], v[144:145] op_sel:[1,0,0] op_sel_hi:[1,1,1]
    v_pk_fma_f32 v[128:129], v[42:43], v[60:61], v[128:129] op_sel:[0,0,0] op_sel_hi:[0,1,1]
    v_pk_fma_f32 v[144:145], v[42:43], v[62:63], v[144:145] op_sel:[0,0,0] op_sel_hi:[0,1,1]
    v_pk_fma_f32 v[130:131], v[42:43], v[144:145], v[130:131] op_sel:[1,0,0] op_sel_hi:[1,1,1] neg_lo:[1,0,0] neg_hi:[1,0,0]
    v_pk_fma_f32 v[146:147], v[42:43], v[128:129], v[146:147] op_sel:[1,0,0] op_sel_hi:[1,1,1]
    v_pk_fma_f32 v[130:131], v[42:43], v[128:129], v[130:131] op_sel:[0,0,0] op_sel_hi:[0,1,1]
    v_pk_fma_f32 v[146:147], v[42:43], v[144:145], v[146:147] op_sel:[0,0,0] op_sel_hi:[0,1,1]
    v_cvt_pk_bf16_f32 v96, v128, -v144
    v_cvt_pk_bf16_f32 v97, v129, -v145
    ds_write2st64_b32 v192, v96, v97 offset0:0 offset1:16
    v_pk_fma_f32 v[132:133], v[42:43], v[146:147], v[132:133] op_sel:[1,0,0] op_sel_hi:[1,1,1] neg_lo:[1,0,0] neg_hi:[1,0,0]
    v_pk_fma_f32 v[148:149], v[42:43], v[130:131], v[148:149] op_sel:[1,0,0] op_sel_hi:[1,1,1]
    v_pk_fma_f32 v[132:133], v[42:43], v[130:131], v[132:133] op_sel:[0,0,0] op_sel_hi:[0,1,1]
    v_pk_fma_f32 v[148:149], v[42:43], v[146:147], v[148:149] op_sel:[0,0,0] op_sel_hi:[0,1,1]
    v_cvt_pk_bf16_f32 v98, v130, -v146
    v_cvt_pk_bf16_f32 v99, v131, -v147
    ds_write2st64_b32 v193, v98, v99 offset0:0 offset1:16
    v_pk_fma_f32 v[134:135], v[42:43], v[148:149], v[134:135] op_sel:[1,0,0] op_sel_hi:[1,1,1] neg_lo:[1,0,0] neg_hi:[1,0,0]
    v_pk_fma_f32 v[150:151], v[42:43], v[132:133], v[150:151] op_sel:[1,0,0] op_sel_hi:[1,1,1]
    v_pk_fma_f32 v[134:135], v[42:43], v[132:133], v[134:135] op_sel:[0,0,0] op_sel_hi:[0,1,1]
    v_pk_fma_f32 v[150:151], v[42:43], v[148:149], v[150:151] op_sel:[0,0,0] op_sel_hi:[0,1,1]
    v_cvt_pk_bf16_f32 v100, v132, -v148
    v_cvt_pk_bf16_f32 v101, v133, -v149
    ds_write2st64_b32 v194, v100, v101 offset0:0 offset1:16
    v_pk_fma_f32 v[136:137], v[42:43], v[150:151], v[136:137] op_sel:[1,0,0] op_sel_hi:[1,1,1] neg_lo:[1,0,0] neg_hi:[1,0,0]
    v_pk_fma_f32 v[152:153], v[42:43], v[134:135], v[152:153] op_sel:[1,0,0] op_sel_hi:[1,1,1]
    v_pk_fma_f32 v[136:137], v[42:43], v[134:135], v[136:137] op_sel:[0,0,0] op_sel_hi:[0,1,1]
    v_pk_fma_f32 v[152:153], v[42:43], v[150:151], v[152:153] op_sel:[0,0,0] op_sel_hi:[0,1,1]
    v_cvt_pk_bf16_f32 v102, v134, -v150
    v_cvt_pk_bf16_f32 v103, v135, -v151
    ds_write2st64_b32 v195, v102, v103 offset0:0 offset1:16
    v_pk_fma_f32 v[138:139], v[42:43], v[152:153], v[138:139] op_sel:[1,0,0] op_sel_hi:[1,1,1] neg_lo:[1,0,0] neg_hi:[1,0,0]
    v_pk_fma_f32 v[154:155], v[42:43], v[136:137], v[154:155] op_sel:[1,0,0] op_sel_hi:[1,1,1]
    v_pk_fma_f32 v[138:139], v[42:43], v[136:137], v[138:139] op_sel:[0,0,0] op_sel_hi:[0,1,1]
    v_pk_fma_f32 v[154:155], v[42:43], v[152:153], v[154:155] op_sel:[0,0,0] op_sel_hi:[0,1,1]
    v_cvt_pk_bf16_f32 v104, v136, -v152
    v_cvt_pk_bf16_f32 v105, v137, -v153
    ds_write2st64_b32 v196, v104, v105 offset0:0 offset1:16
    v_pk_fma_f32 v[140:141], v[42:43], v[154:155], v[140:141] op_sel:[1,0,0] op_sel_hi:[1,1,1] neg_lo:[1,0,0] neg_hi:[1,0,0]
    v_pk_fma_f32 v[156:157], v[42:43], v[138:139], v[156:157] op_sel:[1,0,0] op_sel_hi:[1,1,1]
    v_pk_fma_f32 v[140:141], v[42:43], v[138:139], v[140:141] op_sel:[0,0,0] op_sel_hi:[0,1,1]
    v_pk_fma_f32 v[156:157], v[42:43], v[154:155], v[156:157] op_sel:[0,0,0] op_sel_hi:[0,1,1]
    v_cvt_pk_bf16_f32 v106, v138, -v154
    v_cvt_pk_bf16_f32 v107, v139, -v155
    ds_write2st64_b32 v197, v106, v107 offset0:0 offset1:16
    v_pk_fma_f32 v[142:143], v[42:43], v[156:157], v[142:143] op_sel:[1,0,0] op_sel_hi:[1,1,1] neg_lo:[1,0,0] neg_hi:[1,0,0]
    v_pk_fma_f32 v[158:159], v[42:43], v[140:141], v[158:159] op_sel:[1,0,0] op_sel_hi:[1,1,1]
    v_pk_fma_f32 v[142:143], v[42:43], v[140:141], v[142:143] op_sel:[0,0,0] op_sel_hi:[0,1,1]
    v_pk_fma_f32 v[158:159], v[42:43], v[156:157], v[158:159] op_sel:[0,0,0] op_sel_hi:[0,1,1]
    v_cvt_pk_bf16_f32 v108, v140, -v156
    v_cvt_pk_bf16_f32 v109, v141, -v157
    ds_write2st64_b32 v198, v108, v109 offset0:0 offset1:16
    v_pk_fma_f32 v[160:161], v[42:43], v[158:159], v[160:161] op_sel:[1,0,0] op_sel_hi:[1,1,1] neg_lo:[1,0,0] neg_hi:[1,0,0]
    v_pk_fma_f32 v[176:177], v[42:43], v[142:143], v[176:177] op_sel:[1,0,0] op_sel_hi:[1,1,1]
    v_pk_fma_f32 v[160:161], v[42:43], v[142:143], v[160:161] op_sel:[0,0,0] op_sel_hi:[0,1,1]
    v_pk_fma_f32 v[176:177], v[42:43], v[158:159], v[176:177] op_sel:[0,0,0] op_sel_hi:[0,1,1]
    v_cvt_pk_bf16_f32 v110, v142, -v158
    v_cvt_pk_bf16_f32 v111, v143, -v159
    ds_write2st64_b32 v199, v110, v111 offset0:0 offset1:16
    v_pk_fma_f32 v[162:163], v[42:43], v[176:177], v[162:163] op_sel:[1,0,0] op_sel_hi:[1,1,1] neg_lo:[1,0,0] neg_hi:[1,0,0]
    v_pk_fma_f32 v[178:179], v[42:43], v[160:161], v[178:179] op_sel:[1,0,0] op_sel_hi:[1,1,1]
    v_pk_fma_f32 v[162:163], v[42:43], v[160:161], v[162:163] op_sel:[0,0,0] op_sel_hi:[0,1,1]
    v_pk_fma_f32 v[178:179], v[42:43], v[176:177], v[178:179] op_sel:[0,0,0] op_sel_hi:[0,1,1]
    v_cvt_pk_bf16_f32 v112, v160, -v176
    v_cvt_pk_bf16_f32 v113, v161, -v177
    ds_write2st64_b32 v200, v112, v113 offset0:0 offset1:16
    v_pk_fma_f32 v[164:165], v[42:43], v[178:179], v[164:165] op_sel:[1,0,0] op_sel_hi:[1,1,1] neg_lo:[1,0,0] neg_hi:[1,0,0]
    v_pk_fma_f32 v[180:181], v[42:43], v[162:163], v[180:181] op_sel:[1,0,0] op_sel_hi:[1,1,1]
    v_pk_fma_f32 v[164:165], v[42:43], v[162:163], v[164:165] op_sel:[0,0,0] op_sel_hi:[0,1,1]
    v_pk_fma_f32 v[180:181], v[42:43], v[178:179], v[180:181] op_sel:[0,0,0] op_sel_hi:[0,1,1]
    v_cvt_pk_bf16_f32 v114, v162, -v178
    v_cvt_pk_bf16_f32 v115, v163, -v179
    ds_write2st64_b32 v201, v114, v115 offset0:0 offset1:16
    v_pk_fma_f32 v[166:167], v[42:43], v[180:181], v[166:167] op_sel:[1,0,0] op_sel_hi:[1,1,1] neg_lo:[1,0,0] neg_hi:[1,0,0]
    v_pk_fma_f32 v[182:183], v[42:43], v[164:165], v[182:183] op_sel:[1,0,0] op_sel_hi:[1,1,1]
    v_pk_fma_f32 v[166:167], v[42:43], v[164:165], v[166:167] op_sel:[0,0,0] op_sel_hi:[0,1,1]
    v_pk_fma_f32 v[182:183], v[42:43], v[180:181], v[182:183] op_sel:[0,0,0] op_sel_hi:[0,1,1]
    v_cvt_pk_bf16_f32 v116, v164, -v180
    v_cvt_pk_bf16_f32 v117, v165, -v181
    ds_write2st64_b32 v202, v116, v117 offset0:0 offset1:16
    v_pk_fma_f32 v[168:169], v[42:43], v[182:183], v[168:169] op_sel:[1,0,0] op_sel_hi:[1,1,1] neg_lo:[1,0,0] neg_hi:[1,0,0]
    v_pk_fma_f32 v[184:185], v[42:43], v[166:167], v[184:185] op_sel:[1,0,0] op_sel_hi:[1,1,1]
    v_pk_fma_f32 v[168:169], v[42:43], v[166:167], v[168:169] op_sel:[0,0,0] op_sel_hi:[0,1,1]
    v_pk_fma_f32 v[184:185], v[42:43], v[182:183], v[184:185] op_sel:[0,0,0] op_sel_hi:[0,1,1]
    v_cvt_pk_bf16_f32 v118, v166, -v182
    v_cvt_pk_bf16_f32 v119, v167, -v183
    ds_write2st64_b32 v203, v118, v119 offset0:0 offset1:16
    v_pk_fma_f32 v[170:171], v[42:43], v[184:185], v[170:171] op_sel:[1,0,0] op_sel_hi:[1,1,1] neg_lo:[1,0,0] neg_hi:[1,0,0]
    v_pk_fma_f32 v[186:187], v[42:43], v[168:169], v[186:187] op_sel:[1,0,0] op_sel_hi:[1,1,1]
    v_pk_fma_f32 v[170:171], v[42:43], v[168:169], v[170:171] op_sel:[0,0,0] op_sel_hi:[0,1,1]
    v_pk_fma_f32 v[186:187], v[42:43], v[184:185], v[186:187] op_sel:[0,0,0] op_sel_hi:[0,1,1]
    v_cvt_pk_bf16_f32 v120, v168, -v184
    v_cvt_pk_bf16_f32 v121, v169, -v185
    ds_write2st64_b32 v204, v120, v121 offset0:0 offset1:16
    v_pk_fma_f32 v[172:173], v[42:43], v[186:187], v[172:173] op_sel:[1,0,0] op_sel_hi:[1,1,1] neg_lo:[1,0,0] neg_hi:[1,0,0]
    v_pk_fma_f32 v[188:189], v[42:43], v[170:171], v[188:189] op_sel:[1,0,0] op_sel_hi:[1,1,1]
    v_pk_fma_f32 v[172:173], v[42:43], v[170:171], v[172:173] op_sel:[0,0,0] op_sel_hi:[0,1,1]
    v_pk_fma_f32 v[188:189], v[42:43], v[186:187], v[188:189] op_sel:[0,0,0] op_sel_hi:[0,1,1]
    v_cvt_pk_bf16_f32 v122, v170, -v186
    v_cvt_pk_bf16_f32 v123, v171, -v187
    ds_write2st64_b32 v205, v122, v123 offset0:0 offset1:16
    v_pk_fma_f32 v[174:175], v[42:43], v[188:189], v[174:175] op_sel:[1,0,0] op_sel_hi:[1,1,1] neg_lo:[1,0,0] neg_hi:[1,0,0]
    v_pk_fma_f32 v[190:191], v[42:43], v[172:173], v[190:191] op_sel:[1,0,0] op_sel_hi:[1,1,1]
    v_pk_fma_f32 v[174:175], v[42:43], v[172:173], v[174:175] op_sel:[0,0,0] op_sel_hi:[0,1,1]
    v_pk_fma_f32 v[190:191], v[42:43], v[188:189], v[190:191] op_sel:[0,0,0] op_sel_hi:[0,1,1]
    v_cvt_pk_bf16_f32 v124, v172, -v188
    v_cvt_pk_bf16_f32 v125, v173, -v189
    ds_write2st64_b32 v206, v124, v125 offset0:0 offset1:16
    v_cvt_pk_bf16_f32 v126, v174, -v190
    v_cvt_pk_bf16_f32 v127, v175, -v191
    ds_write2st64_b32 v207, v126, v127 offset0:0 offset1:16
    ds_read_b128 v[128:131], v24 offset:0
    ds_read_b128 v[132:135], v24 offset:4096
    ds_read_b128 v[136:139], v24 offset:2048
    ds_read_b128 v[140:143], v24 offset:6144
    ds_read_b128 v[144:147], v25 offset:0
    ds_read_b128 v[148:151], v25 offset:4096
    ds_read_b128 v[152:155], v25 offset:2048
    ds_read_b128 v[156:159], v25 offset:6144
    s_waitcnt lgkmcnt(7)
    buffer_store_dwordx4 v[128:131], v248, s[56:59], s74 offen offset:0 sc1
    s_waitcnt lgkmcnt(6)
    buffer_store_dwordx4 v[132:135], v248, s[56:59], s74 offen offset:1024 sc1
    s_waitcnt lgkmcnt(5)
    buffer_store_dwordx4 v[136:139], v248, s[56:59], s74 offen offset:2048 sc1
    s_waitcnt lgkmcnt(4)
    buffer_store_dwordx4 v[140:143], v248, s[56:59], s74 offen offset:3072 sc1
    s_waitcnt lgkmcnt(3)
    buffer_store_dwordx4 v[144:147], v248, s[56:59], s75 offen offset:0 sc1
    s_waitcnt lgkmcnt(2)
    buffer_store_dwordx4 v[148:151], v248, s[56:59], s75 offen offset:1024 sc1
    s_waitcnt lgkmcnt(1)
    buffer_store_dwordx4 v[152:155], v248, s[56:59], s75 offen offset:2048 sc1
    s_waitcnt lgkmcnt(0)
    buffer_store_dwordx4 v[156:159], v248, s[56:59], s75 offen offset:3072 sc1
    s_waitcnt vmcnt(8)
    v_cmp_ne_u32 vcc, s47, v250
    s_nop 1
    s_cmp_eq_u64 vcc, 0
    s_cbranch_scc1 L_ssm_w_ok
    buffer_load_dword v250, v251, s[56:59], 0 offen sc0 sc1
    s_mov_b32 s43, 0
L_wc_ssm:
    s_waitcnt vmcnt(0)
    v_cmp_ne_u32 vcc, s47, v250
    s_nop 1
    s_cmp_eq_u64 vcc, 0
    s_cbranch_scc1 L_wc_done_ssm
    s_add_u32 s43, s43, 1
    s_cmp_lt_u32 s43, 0x100000
    s_cbranch_scc0 L_wc_done_ssm
    buffer_load_dword v250, v251, s[56:59], 0 offen sc0 sc1
    s_branch L_wc_ssm
L_wc_done_ssm:
L_ssm_w_ok:
    s_mov_b32 s71, 0
    buffer_load_dwordx4 a[0:3], v248, s[52:55], s71 offen offset:0 sc1
    buffer_load_dwordx4 a[4:7], v248, s[52:55], s71 offen offset:1024 sc1
    buffer_load_dwordx4 a[8:11], v248, s[52:55], s71 offen offset:2048 sc1
    buffer_load_dwordx4 a[12:15], v248, s[52:55], s71 offen offset:3072 sc1
    buffer_load_dwordx4 a[16:19], v249, s[52:55], s71 offen sc1
    s_mov_b32 s71, 5120
    buffer_load_dwordx4 a[20:23], v248, s[52:55], s71 offen offset:0 sc1
    buffer_load_dwordx4 a[24:27], v248, s[52:55], s71 offen offset:1024 sc1
    buffer_load_dwordx4 a[28:31], v248, s[52:55], s71 offen offset:2048 sc1
    buffer_load_dwordx4 a[32:35], v248, s[52:55], s71 offen offset:3072 sc1
    buffer_load_dwordx4 a[36:39], v249, s[52:55], s71 offen sc1
    s_mov_b32 s71, 10240
    buffer_load_dwordx4 a[40:43], v248, s[52:55], s71 offen offset:0 sc1
    buffer_load_dwordx4 a[44:47], v248, s[52:55], s71 offen offset:1024 sc1
    buffer_load_dwordx4 a[48:51], v248, s[52:55], s71 offen offset:2048 sc1
    buffer_load_dwordx4 a[52:55], v248, s[52:55], s71 offen offset:3072 sc1
    s_mul_i32 s41, s38, 22
    s_mul_i32 s42, s22, 88
    s_add_u32 s42, s42, s41
    s_lshl_b32 s42, s42, 12
    s_add_u32 s60, s34, s42
    s_addc_u32 s61, s35, 0
    s_mov_b32 s62, 90112
    s_mov_b32 s63, 0x20000
    s_waitcnt vmcnt(14)
    s_barrier
    s_cmp_lg_u32 s38, 0
    s_cbranch_scc1 L_sig_ssm
    v_mov_b32 v124, s98
    v_mov_b32 v125, s47
    s_mov_b64 exec, 1
    buffer_store_dword v125, v124, s[56:59], 0 offen sc0 sc1
    s_mov_b64 exec, -1
L_sig_ssm:
    buffer_load_dwordx4 a[56:59], v249, s[52:55], s71 offen sc1
    s_mov_b32 s71, 15360
    buffer_load_dwordx4 a[60:63], v248, s[52:55], s71 offen offset:0 sc1
    buffer_load_dwordx4 a[64:67], v248, s[52:55], s71 offen offset:1024 sc1
    buffer_load_dwordx4 a[68:71], v248, s[52:55], s71 offen offset:2048 sc1
    buffer_load_dwordx4 a[72:75], v248, s[52:55], s71 offen offset:3072 sc1
    buffer_load_dwordx4 a[76:79], v249, s[52:55], s71 offen sc1
    s_mov_b32 s71, 20480
    buffer_load_dwordx4 a[80:83], v248, s[52:55], s71 offen offset:0 sc1
    buffer_load_dwordx4 a[84:87], v248, s[52:55], s71 offen offset:1024 sc1
    buffer_load_dwordx4 a[88:91], v248, s[52:55], s71 offen offset:2048 sc1
    buffer_load_dwordx4 a[92:95], v248, s[52:55], s71 offen offset:3072 sc1
    buffer_load_dwordx4 a[96:99], v249, s[52:55], s71 offen sc1
    s_mov_b32 s71, 25600
    buffer_load_dwordx4 a[100:103], v248, s[52:55], s71 offen offset:0 sc1
    buffer_load_dwordx4 a[104:107], v248, s[52:55], s71 offen offset:1024 sc1
    buffer_load_dwordx4 a[108:111], v248, s[52:55], s71 offen offset:2048 sc1
    buffer_load_dwordx4 a[112:115], v248, s[52:55], s71 offen offset:3072 sc1
    buffer_load_dwordx4 a[116:119], v249, s[52:55], s71 offen sc1
    s_mov_b32 s71, 30720
    buffer_load_dwordx4 a[120:123], v248, s[52:55], s71 offen offset:0 sc1
    buffer_load_dwordx4 a[124:127], v248, s[52:55], s71 offen offset:1024 sc1
    buffer_load_dwordx4 a[128:131], v248, s[52:55], s71 offen offset:2048 sc1
    buffer_load_dwordx4 a[132:135], v248, s[52:55], s71 offen offset:3072 sc1
    buffer_load_dwordx4 a[136:139], v249, s[52:55], s71 offen sc1
    s_mov_b32 s71, 35840
    buffer_load_dwordx4 a[140:143], v248, s[52:55], s71 offen offset:0 sc1
    buffer_load_dwordx4 a[144:147], v248, s[52:55], s71 offen offset:1024 sc1
    buffer_load_dwordx4 a[148:151], v248, s[52:55], s71 offen offset:2048 sc1
    buffer_load_dwordx4 a[152:155], v248, s[52:55], s71 offen offset:3072 sc1
    buffer_load_dwordx4 a[156:159], v249, s[52:55], s71 offen sc1
    s_mov_b32 s71, 40960
    buffer_load_dwordx4 a[160:163], v248, s[52:55], s71 offen offset:0 sc1
    buffer_load_dwordx4 a[164:167], v248, s[52:55], s71 offen offset:1024 sc1
    buffer_load_dwordx4 a[168:171], v248, s[52:55], s71 offen offset:2048 sc1
    buffer_load_dwordx4 a[172:175], v248, s[52:55], s71 offen offset:3072 sc1
    buffer_load_dwordx4 a[176:179], v249, s[52:55], s71 offen sc1
    s_cmp_lg_u32 s38, 0
    s_cbranch_scc1 L_ep_ssm
    s_lshr_b32 s41, s22, 1
    s_lshl_b32 s41, s41, 4
    v_add_u32 v5, s41, v1
    v_lshlrev_b32 v5, 7, v5
    v_add_u32 v5, 15310848, v5
    s_mov_b32 exec_lo, 0xffff
    s_mov_b32 exec_hi, 0
    buffer_load_dword v4, v5, s[56:59], 0 offen sc0 sc1
    s_mov_b64 exec, -1
L_ep_ssm:
    s_mov_b32 s71, 46080
    buffer_load_dwordx4 a[180:183], v248, s[52:55], s71 offen offset:0 sc1
    buffer_load_dwordx4 a[184:187], v248, s[52:55], s71 offen offset:1024 sc1
    buffer_load_dwordx4 a[188:191], v248, s[52:55], s71 offen offset:2048 sc1
    buffer_load_dwordx4 a[192:195], v248, s[52:55], s71 offen offset:3072 sc1
    buffer_load_dwordx4 a[196:199], v249, s[52:55], s71 offen sc1
    s_mov_b32 s71, 51200
    buffer_load_dwordx4 a[200:203], v248, s[52:55], s71 offen offset:0 sc1
    buffer_load_dwordx4 a[204:207], v248, s[52:55], s71 offen offset:1024 sc1
    buffer_load_dwordx4 a[208:211], v248, s[52:55], s71 offen offset:2048 sc1
    buffer_load_dwordx4 a[212:215], v248, s[52:55], s71 offen offset:3072 sc1
    buffer_load_dwordx4 a[216:219], v249, s[52:55], s71 offen sc1
    s_mov_b32 s71, 56320
    buffer_load_dwordx4 a[220:223], v248, s[52:55], s71 offen offset:0 sc1
    buffer_load_dwordx4 a[224:227], v248, s[52:55], s71 offen offset:1024 sc1
    buffer_load_dwordx4 a[228:231], v248, s[52:55], s71 offen offset:2048 sc1
    buffer_load_dwordx4 a[232:235], v248, s[52:55], s71 offen offset:3072 sc1
    buffer_load_dwordx4 a[236:239], v249, s[52:55], s71 offen sc1
    s_branch L_phase2
L_ffn:
    s_mul_i32 s43, s43, 3
    s_add_u32 s37, s43, s42
    s_sub_u32 s37, s37, 5
    s_lshr_b32 s39, s38, 1
    s_and_b32 s40, s38, 1
    v_lshrrev_b32 v2, 4, v1
    v_and_b32 v3, 7, v1
    v_xor_b32 v3, v2, v3
    v_lshlrev_b32 v3, 4, v3
    v_xor_b32 v4, 64, v3
    s_lshl_b32 s41, s36, 7
    s_lshl_b32 s42, s38, 5
    s_add_u32 s41, s41, s42
    v_lshrrev_b32 v5, 3, v1
    v_add_u32 v5, s41, v5
    v_mul_u32_u24 v5, 1280, v5
    v_add_u32 v10, v5, v3
    v_add_u32 v11, v5, v4
    v_add_u32 v11, 9216, v11
    v_add_u32 v12, v5, v3
    v_add_u32 v12, 18432, v12
    v_add_u32 v13, v5, v4
    v_add_u32 v13, 27648, v13
    v_lshrrev_b32 v2, 5, v1
    s_lshl_b32 s41, s38, 4
    v_add_u32 v5, s41, v2
    v_mul_u32_u24 v5, 3072, v5
    s_lshl_b32 s41, s37, 9
    v_add_u32 v5, s41, v5
    v_and_b32 v6, 31, v1
    v_lshlrev_b32 v7, 2, v2
    v_xor_b32 v6, v6, v7
    v_lshlrev_b32 v6, 4, v6
    v_xor_b32 v7, 128, v6
    v_add_u32 v14, v5, v6
    v_add_u32 v15, v5, v7
    v_add_u32 v15, 5120, v15
    v_add_u32 v16, v5, v6
    v_add_u32 v16, 10240, v16
    v_add_u32 v17, v5, v7
    v_add_u32 v17, 15360, v17
    v_add_u32 v18, v5, v6
    v_add_u32 v18, 24576, v18
    v_add_u32 v19, v5, v7
    v_add_u32 v19, 29696, v19
    v_add_u32 v20, v5, v6
    v_add_u32 v20, 34816, v20
    v_add_u32 v21, v5, v7
    v_add_u32 v21, 39936, v21
    s_lshl_b32 s69, s38, 12
    s_lshl_b32 s70, s38, 13
    s_add_u32 s70, s70, 16384
    v_lshlrev_b32 v48, 4, v1
    v_add_u32 v49, 4096, v48
    s_waitcnt lgkmcnt(0)
    s_mov_b32 s48, s4
    s_mov_b32 s49, s5
    s_mov_b32 s50, 2621440
    s_mov_b32 s51, 0x20000
    s_mov_b32 s52, s24
    s_mov_b32 s53, s25
    s_mov_b32 s54, 1966080
    s_mov_b32 s55, 0x20000
    s_add_u32 m0, s69, 0
    s_mul_i32 s71, s68, 1536
    buffer_load_dwordx4 v10, s[48:51], s68 offen offset:0 lds
    buffer_load_dwordx4 v11, s[48:51], s68 offen offset:1024 lds
    buffer_load_dwordx4 v12, s[48:51], s68 offen offset:2048 lds
    buffer_load_dwordx4 v13, s[48:51], s68 offen offset:3072 lds
    s_add_u32 m0, s70, 0
    s_nop 0
    buffer_load_dwordx4 v14, s[52:55], s71 offen offset:0 lds
    buffer_load_dwordx4 v15, s[52:55], s71 offen offset:1024 lds
    buffer_load_dwordx4 v16, s[52:55], s71 offen offset:2048 lds
    buffer_load_dwordx4 v17, s[52:55], s71 offen offset:3072 lds
    s_add_u32 m0, s70, 4096
    s_nop 0
    buffer_load_dwordx4 v18, s[52:55], s71 offen offset:0 lds
    buffer_load_dwordx4 v19, s[52:55], s71 offen offset:1024 lds
    buffer_load_dwordx4 v20, s[52:55], s71 offen offset:2048 lds
    buffer_load_dwordx4 v21, s[52:55], s71 offen offset:3072 lds
    s_lshr_b32 s44, s2, 3
    s_or_b32 s44, s44, s38
    s_cmp_lg_u32 s44, 0
    s_cbranch_scc1 L_no_offer_ffn
    s_memrealtime s[44:45]
    s_waitcnt lgkmcnt(0)
    s_or_b32 s44, s44, 1
    v_mov_b32 v124, s44
    v_mov_b32 v125, 0
    v_mov_b32 v122, 0
    s_mov_b64 exec, 1
    global_atomic_cmpswap v122, v[124:125], s[32:33] sc1
    s_mov_b64 exec, -1
L_no_offer_ffn:
    s_mov_b32 s56, s34
    s_mov_b32 s57, s35
    s_mov_b32 s58, 33554432
    s_mov_b32 s59, 0x20000
    s_add_u32 s68, s68, 128
    s_cmp_eq_u32 s68, 1280
    s_cselect_b32 s68, 0, s68
    s_add_u32 m0, s69, 49152
    s_mul_i32 s71, s68, 1536
    buffer_load_dwordx4 v10, s[48:51], s68 offen offset:0 lds
    s_and_b32 s44, s2, 3
    s_lshl_b32 s44, s44, 3
    s_bfe_u32 s45, s2, 0x30003
    s_add_u32 s22, s44, s45
    buffer_load_dwordx4 v11, s[48:51], s68 offen offset:1024 lds
    s_bfe_u32 s44, s2, 0x10002
    s_lshl_b32 s44, s44, 2
    s_lshr_b32 s45, s2, 6
    buffer_load_dwordx4 v12, s[48:51], s68 offen offset:2048 lds
    s_add_u32 s23, s44, s45
    v_and_b32 v9, 31, v1
    v_lshrrev_b32 v2, 5, v1
    v_bfe_u32 v3, v1, 1, 3
    buffer_load_dwordx4 v13, s[48:51], s68 offen offset:3072 lds
    v_xor_b32 v2, v2, v3
    v_lshlrev_b32 v2, 4, v2
    v_lshl_add_u32 v2, v9, 7, v2
    s_add_u32 m0, s70, 49152
    s_nop 0
    buffer_load_dwordx4 v14, s[52:55], s71 offen offset:0 lds
    s_lshl_b32 s41, s39, 13
    v_add_u32 v2, s41, v2
    v_mov_b32 v22, v2
    v_mov_b32 v26, v2
    buffer_load_dwordx4 v15, s[52:55], s71 offen offset:1024 lds
    v_add_u32 v26, 49152, v26
    v_mov_b32 v30, v2
    v_add_u32 v30, 98304, v30
    buffer_load_dwordx4 v16, s[52:55], s71 offen offset:2048 lds
    v_xor_b32 v23, 32, v2
    v_xor_b32 v27, 32, v2
    v_add_u32 v27, 49152, v27
    v_xor_b32 v31, 32, v2
    buffer_load_dwordx4 v17, s[52:55], s71 offen offset:3072 lds
    v_add_u32 v31, 98304, v31
    v_xor_b32 v24, 64, v2
    v_xor_b32 v28, 64, v2
    v_add_u32 v28, 49152, v28
    s_add_u32 m0, s70, 53248
    s_nop 0
    buffer_load_dwordx4 v18, s[52:55], s71 offen offset:0 lds
    v_xor_b32 v32, 64, v2
    v_add_u32 v32, 98304, v32
    v_xor_b32 v25, 96, v2
    buffer_load_dwordx4 v19, s[52:55], s71 offen offset:1024 lds
    v_xor_b32 v29, 96, v2
    v_add_u32 v29, 49152, v29
    v_xor_b32 v33, 96, v2
    v_add_u32 v33, 98304, v33
    buffer_load_dwordx4 v20, s[52:55], s71 offen offset:2048 lds
    v_lshrrev_b32 v2, 5, v1
    v_lshlrev_b32 v2, 3, v2
    v_bfe_u32 v3, v1, 2, 2
    buffer_load_dwordx4 v21, s[52:55], s71 offen offset:3072 lds
    v_add_u32 v2, v2, v3
    v_lshlrev_b32 v2, 9, v2
    v_bfe_u32 v4, v1, 4, 1
    v_lshl_add_u32 v2, v4, 5, v2
    s_add_u32 s68, s68, 128
    s_cmp_eq_u32 s68, 1280
    s_cselect_b32 s68, 0, s68
    s_add_u32 m0, s69, 98304
    s_mul_i32 s71, s68, 1536
    buffer_load_dwordx4 v10, s[48:51], s68 offen offset:0 lds
    v_and_b32 v4, 3, v1
    v_lshl_add_u32 v2, v4, 3, v2
    v_lshl_add_u32 v2, v3, 6, v2
    buffer_load_dwordx4 v11, s[48:51], s68 offen offset:1024 lds
    s_lshl_b32 s41, s40, 8
    s_add_u32 s41, s41, 16384
    v_add_u32 v2, s41, v2
    v_mov_b32 v34, v2
    buffer_load_dwordx4 v12, s[48:51], s68 offen offset:2048 lds
    v_mov_b32 v38, v2
    v_add_u32 v38, 49152, v38
    v_mov_b32 v42, v2
    buffer_load_dwordx4 v13, s[48:51], s68 offen offset:3072 lds
    v_add_u32 v42, 98304, v42
    v_xor_b32 v35, 64, v2
    v_xor_b32 v39, 64, v2
    v_add_u32 v39, 49152, v39
    s_add_u32 m0, s70, 98304
    s_nop 0
    buffer_load_dwordx4 v14, s[52:55], s71 offen offset:0 lds
    v_xor_b32 v43, 64, v2
    v_add_u32 v43, 98304, v43
    v_xor_b32 v36, 128, v2
    v_xor_b32 v40, 128, v2
    buffer_load_dwordx4 v15, s[52:55], s71 offen offset:1024 lds
    v_add_u32 v40, 49152, v40
    v_xor_b32 v44, 128, v2
    v_add_u32 v44, 98304, v44
    buffer_load_dwordx4 v16, s[52:55], s71 offen offset:2048 lds
    v_xor_b32 v37, 192, v2
    v_xor_b32 v41, 192, v2
    v_add_u32 v41, 49152, v41
    v_xor_b32 v45, 192, v2
    buffer_load_dwordx4 v17, s[52:55], s71 offen offset:3072 lds
    v_add_u32 v45, 98304, v45
    s_lshl_b32 s98, s36, 4
    s_add_u32 s98, s98, s37
    s_add_u32 m0, s70, 102400
    s_nop 0
    buffer_load_dwordx4 v18, s[52:55], s71 offen offset:0 lds
    s_add_u32 s98, s98, 10
    s_lshl_b32 s98, s98, 7
    s_add_u32 s98, s98, 15310848
    v_min_u32 v2, 39, v1
    buffer_load_dwordx4 v19, s[52:55], s71 offen offset:1024 lds
    v_mul_u32_u24 v3, 0x199a, v2
    v_lshrrev_b32 v3, 16, v3
    v_mul_u32_u24 v51, 10, v3
    buffer_load_dwordx4 v20, s[52:55], s71 offen offset:2048 lds
    v_sub_u32 v2, v2, v51
    s_lshr_b32 s41, s23, 1
    s_lshl_b32 s41, s41, 2
    v_add_u32 v3, s41, v3
    buffer_load_dwordx4 v21, s[52:55], s71 offen offset:3072 lds
    v_lshl_add_u32 v51, v3, 4, v2
    v_lshlrev_b32 v51, 7, v51
    v_add_u32 v51, 15343616, v51
    s_waitcnt vmcnt(24)
    s_barrier
    ds_read_b128 a[0:3], v22 offset:0
    ds_read_b128 a[16:19], v22 offset:4096
    ds_read_b64_tr_b16 a[32:33], v34 offset:0
    ds_read_b64_tr_b16 a[34:35], v34 offset:2048
    ds_read_b64_tr_b16 a[48:49], v35 offset:0
    ds_read_b64_tr_b16 a[50:51], v35 offset:2048
    ds_read_b64_tr_b16 a[64:65], v36 offset:0
    ds_read_b64_tr_b16 a[66:67], v36 offset:2048
    ds_read_b64_tr_b16 a[80:81], v37 offset:0
    ds_read_b64_tr_b16 a[82:83], v37 offset:2048
    ds_read_b128 a[4:7], v23 offset:0
    ds_read_b128 a[20:23], v23 offset:4096
    ds_read_b64_tr_b16 a[36:37], v34 offset:8192
    ds_read_b64_tr_b16 a[38:39], v34 offset:10240
    ds_read_b64_tr_b16 a[52:53], v35 offset:8192
    ds_read_b64_tr_b16 a[54:55], v35 offset:10240
    ds_read_b64_tr_b16 a[68:69], v36 offset:8192
    ds_read_b64_tr_b16 a[70:71], v36 offset:10240
    ds_read_b64_tr_b16 a[84:85], v37 offset:8192
    ds_read_b64_tr_b16 a[86:87], v37 offset:10240
    ds_read_b128 a[8:11], v24 offset:0
    ds_read_b128 a[24:27], v24 offset:4096
    ds_read_b64_tr_b16 a[40:41], v34 offset:16384
    ds_read_b64_tr_b16 a[42:43], v34 offset:18432
    ds_read_b64_tr_b16 a[56:57], v35 offset:16384
    ds_read_b64_tr_b16 a[58:59], v35 offset:18432
    ds_read_b64_tr_b16 a[72:73], v36 offset:16384
    ds_read_b64_tr_b16 a[74:75], v36 offset:18432
    ds_read_b64_tr_b16 a[88:89], v37 offset:16384
    ds_read_b64_tr_b16 a[90:91], v37 offset:18432
    ds_read_b128 a[12:15], v25 offset:0
    ds_read_b128 a[28:31], v25 offset:4096
    ds_read_b64_tr_b16 a[44:45], v34 offset:24576
    ds_read_b64_tr_b16 a[46:47], v34 offset:26624
    ds_read_b64_tr_b16 a[60:61], v35 offset:24576
    ds_read_b64_tr_b16 a[62:63], v35 offset:26624
    ds_read_b64_tr_b16 a[76:77], v36 offset:24576
    ds_read_b64_tr_b16 a[78:79], v36 offset:26624
    ds_read_b64_tr_b16 a[92:93], v37 offset:24576
    ds_read_b64_tr_b16 a[94:95], v37 offset:26624
    s_waitcnt lgkmcnt(0)
    v_mfma_f32_32x32x16_bf16 v[128:143], a[32:35], a[0:3], 0
    v_mfma_f32_32x32x16_bf16 v[144:159], a[32:35], a[16:19], 0
    s_waitcnt vmcnt(12)
    s_barrier
    v_mfma_f32_32x32x16_bf16 v[160:175], a[48:51], a[0:3], 0
    ds_read_b128 a[96:99], v26 offset:0
    ds_read_b128 a[112:115], v26 offset:4096
    s_add_u32 s68, s68, 128
    s_cmp_eq_u32 s68, 1280
    s_cselect_b32 s68, 0, s68
    s_add_u32 m0, s69, 0
    s_mul_i32 s71, s68, 1536
    buffer_load_dwordx4 v10, s[48:51], s68 offen offset:0 lds
    v_mfma_f32_32x32x16_bf16 v[176:191], a[48:51], a[16:19], 0
    ds_read_b64_tr_b16 a[128:129], v38 offset:0
    ds_read_b64_tr_b16 a[130:131], v38 offset:2048
    v_mfma_f32_32x32x16_bf16 v[192:207], a[64:67], a[0:3], 0
    ds_read_b64_tr_b16 a[144:145], v39 offset:0
    ds_read_b64_tr_b16 a[146:147], v39 offset:2048
    v_mfma_f32_32x32x16_bf16 v[208:223], a[64:67], a[16:19], 0
    ds_read_b64_tr_b16 a[160:161], v40 offset:0
    ds_read_b64_tr_b16 a[162:163], v40 offset:2048
    buffer_load_dwordx4 v11, s[48:51], s68 offen offset:1024 lds
    v_mfma_f32_32x32x16_bf16 v[224:239], a[80:83], a[0:3], 0
    ds_read_b64_tr_b16 a[176:177], v41 offset:0
    ds_read_b64_tr_b16 a[178:179], v41 offset:2048
    v_mfma_f32_32x32x16_bf16 v[240:255], a[80:83], a[16:19], 0
    ds_read_b128 a[100:103], v27 offset:0
    ds_read_b128 a[116:119], v27 offset:4096
    buffer_load_dwordx4 v12, s[48:51], s68 offen offset:2048 lds
    v_mfma_f32_32x32x16_bf16 v[128:143], a[36:39], a[4:7], v[128:143]
    ds_read_b64_tr_b16 a[132:133], v38 offset:8192
    ds_read_b64_tr_b16 a[134:135], v38 offset:10240
    v_mfma_f32_32x32x16_bf16 v[144:159], a[36:39], a[20:23], v[144:159]
    ds_read_b64_tr_b16 a[148:149], v39 offset:8192
    ds_read_b64_tr_b16 a[150:151], v39 offset:10240
    v_mfma_f32_32x32x16_bf16 v[160:175], a[52:55], a[4:7], v[160:175]
    ds_read_b64_tr_b16 a[164:165], v40 offset:8192
    ds_read_b64_tr_b16 a[166:167], v40 offset:10240
    buffer_load_dwordx4 v13, s[48:51], s68 offen offset:3072 lds
    v_mfma_f32_32x32x16_bf16 v[176:191], a[52:55], a[20:23], v[176:191]
    ds_read_b64_tr_b16 a[180:181], v41 offset:8192
    ds_read_b64_tr_b16 a[182:183], v41 offset:10240
    v_mfma_f32_32x32x16_bf16 v[192:207], a[68:71], a[4:7], v[192:207]
    ds_read_b128 a[104:107], v28 offset:0
    ds_read_b128 a[120:123], v28 offset:4096
    s_add_u32 m0, s70, 0
    s_nop 0
    buffer_load_dwordx4 v14, s[52:55], s71 offen offset:0 lds
    v_mfma_f32_32x32x16_bf16 v[208:223], a[68:71], a[20:23], v[208:223]
    ds_read_b64_tr_b16 a[136:137], v38 offset:16384
    ds_read_b64_tr_b16 a[138:139], v38 offset:18432
    v_mfma_f32_32x32x16_bf16 v[224:239], a[84:87], a[4:7], v[224:239]
    ds_read_b64_tr_b16 a[152:153], v39 offset:16384
    ds_read_b64_tr_b16 a[154:155], v39 offset:18432
    v_mfma_f32_32x32x16_bf16 v[240:255], a[84:87], a[20:23], v[240:255]
    ds_read_b64_tr_b16 a[168:169], v40 offset:16384
    ds_read_b64_tr_b16 a[170:171], v40 offset:18432
    buffer_load_dwordx4 v15, s[52:55], s71 offen offset:1024 lds
    v_mfma_f32_32x32x16_bf16 v[128:143], a[40:43], a[8:11], v[128:143]
    ds_read_b64_tr_b16 a[184:185], v41 offset:16384
    ds_read_b64_tr_b16 a[186:187], v41 offset:18432
    v_mfma_f32_32x32x16_bf16 v[144:159], a[40:43], a[24:27], v[144:159]
    ds_read_b128 a[108:111], v29 offset:0
    ds_read_b128 a[124:127], v29 offset:4096
    buffer_load_dwordx4 v16, s[52:55], s71 offen offset:2048 lds
    v_mfma_f32_32x32x16_bf16 v[160:175], a[56:59], a[8:11], v[160:175]
    ds_read_b64_tr_b16 a[140:141], v38 offset:24576
    ds_read_b64_tr_b16 a[142:143], v38 offset:26624
    v_mfma_f32_32x32x16_bf16 v[176:191], a[56:59], a[24:27], v[176:191]
    ds_read_b64_tr_b16 a[156:157], v39 offset:24576
    ds_read_b64_tr_b16 a[158:159], v39 offset:26624
    v_mfma_f32_32x32x16_bf16 v[192:207], a[72:75], a[8:11], v[192:207]
    ds_read_b64_tr_b16 a[172:173], v40 offset:24576
    ds_read_b64_tr_b16 a[174:175], v40 offset:26624
    buffer_load_dwordx4 v17, s[52:55], s71 offen offset:3072 lds
    v_mfma_f32_32x32x16_bf16 v[208:223], a[72:75], a[24:27], v[208:223]
    ds_read_b64_tr_b16 a[188:189], v41 offset:24576
    ds_read_b64_tr_b16 a[190:191], v41 offset:26624
    v_mfma_f32_32x32x16_bf16 v[224:239], a[88:91], a[8:11], v[224:239]
    s_add_u32 m0, s70, 4096
    s_nop 0
    buffer_load_dwordx4 v18, s[52:55], s71 offen offset:0 lds
    v_mfma_f32_32x32x16_bf16 v[240:255], a[88:91], a[24:27], v[240:255]
    v_mfma_f32_32x32x16_bf16 v[128:143], a[44:47], a[12:15], v[128:143]
    v_mfma_f32_32x32x16_bf16 v[144:159], a[44:47], a[28:31], v[144:159]
    buffer_load_dwordx4 v19, s[52:55], s71 offen offset:1024 lds
    v_mfma_f32_32x32x16_bf16 v[160:175], a[60:63], a[12:15], v[160:175]
    v_mfma_f32_32x32x16_bf16 v[176:191], a[60:63], a[28:31], v[176:191]
    buffer_load_dwordx4 v20, s[52:55], s71 offen offset:2048 lds
    v_mfma_f32_32x32x16_bf16 v[192:207], a[76:79], a[12:15], v[192:207]
    v_mfma_f32_32x32x16_bf16 v[208:223], a[76:79], a[28:31], v[208:223]
    v_mfma_f32_32x32x16_bf16 v[224:239], a[92:95], a[12:15], v[224:239]
    buffer_load_dwordx4 v21, s[52:55], s71 offen offset:3072 lds
    v_mfma_f32_32x32x16_bf16 v[240:255], a[92:95], a[28:31], v[240:255]
    s_waitcnt lgkmcnt(0)
    v_mfma_f32_32x32x16_bf16 v[128:143], a[128:131], a[96:99], v[128:143]
    v_mfma_f32_32x32x16_bf16 v[144:159], a[128:131], a[112:115], v[144:159]
    s_waitcnt vmcnt(12)
    s_barrier
    v_mfma_f32_32x32x16_bf16 v[160:175], a[144:147], a[96:99], v[160:175]
    ds_read_b128 a[0:3], v30 offset:0
    ds_read_b128 a[16:19], v30 offset:4096
    s_add_u32 s68, s68, 128
    s_cmp_eq_u32 s68, 1280
    s_cselect_b32 s68, 0, s68
    s_add_u32 m0, s69, 49152
    s_mul_i32 s71, s68, 1536
    buffer_load_dwordx4 v10, s[48:51], s68 offen offset:0 lds
    v_mfma_f32_32x32x16_bf16 v[176:191], a[144:147], a[112:115], v[176:191]
    ds_read_b64_tr_b16 a[32:33], v42 offset:0
    ds_read_b64_tr_b16 a[34:35], v42 offset:2048
    v_mfma_f32_32x32x16_bf16 v[192:207], a[160:163], a[96:99], v[192:207]
    ds_read_b64_tr_b16 a[48:49], v43 offset:0
    ds_read_b64_tr_b16 a[50:51], v43 offset:2048
    v_mfma_f32_32x32x16_bf16 v[208:223], a[160:163], a[112:115], v[208:223]
    ds_read_b64_tr_b16 a[64:65], v44 offset:0
    ds_read_b64_tr_b16 a[66:67], v44 offset:2048
    buffer_load_dwordx4 v11, s[48:51], s68 offen offset:1024 lds
    v_mfma_f32_32x32x16_bf16 v[224:239], a[176:179], a[96:99], v[224:239]
    ds_read_b64_tr_b16 a[80:81], v45 offset:0
    ds_read_b64_tr_b16 a[82:83], v45 offset:2048
    v_mfma_f32_32x32x16_bf16 v[240:255], a[176:179], a[112:115], v[240:255]
    ds_read_b128 a[4:7], v31 offset:0
    ds_read_b128 a[20:23], v31 offset:4096
    buffer_load_dwordx4 v12, s[48:51], s68 offen offset:2048 lds
    v_mfma_f32_32x32x16_bf16 v[128:143], a[132:135], a[100:103], v[128:143]
    ds_read_b64_tr_b16 a[36:37], v42 offset:8192
    ds_read_b64_tr_b16 a[38:39], v42 offset:10240
    v_mfma_f32_32x32x16_bf16 v[144:159], a[132:135], a[116:119], v[144:159]
    ds_read_b64_tr_b16 a[52:53], v43 offset:8192
    ds_read_b64_tr_b16 a[54:55], v43 offset:10240
    v_mfma_f32_32x32x16_bf16 v[160:175], a[148:151], a[100:103], v[160:175]
    ds_read_b64_tr_b16 a[68:69], v44 offset:8192
    ds_read_b64_tr_b16 a[70:71], v44 offset:10240
    buffer_load_dwordx4 v13, s[48:51], s68 offen offset:3072 lds
    v_mfma_f32_32x32x16_bf16 v[176:191], a[148:151], a[116:119], v[176:191]
    ds_read_b64_tr_b16 a[84:85], v45 offset:8192
    ds_read_b64_tr_b16 a[86:87], v45 offset:10240
    v_mfma_f32_32x32x16_bf16 v[192:207], a[164:167], a[100:103], v[192:207]
    ds_read_b128 a[8:11], v32 offset:0
    ds_read_b128 a[24:27], v32 offset:4096
    s_add_u32 m0, s70, 49152
    s_nop 0
    buffer_load_dwordx4 v14, s[52:55], s71 offen offset:0 lds
    v_mfma_f32_32x32x16_bf16 v[208:223], a[164:167], a[116:119], v[208:223]
    ds_read_b64_tr_b16 a[40:41], v42 offset:16384
    ds_read_b64_tr_b16 a[42:43], v42 offset:18432
    v_mfma_f32_32x32x16_bf16 v[224:239], a[180:183], a[100:103], v[224:239]
    ds_read_b64_tr_b16 a[56:57], v43 offset:16384
    ds_read_b64_tr_b16 a[58:59], v43 offset:18432
    v_mfma_f32_32x32x16_bf16 v[240:255], a[180:183], a[116:119], v[240:255]
    ds_read_b64_tr_b16 a[72:73], v44 offset:16384
    ds_read_b64_tr_b16 a[74:75], v44 offset:18432
    buffer_load_dwordx4 v15, s[52:55], s71 offen offset:1024 lds
    v_mfma_f32_32x32x16_bf16 v[128:143], a[136:139], a[104:107], v[128:143]
    ds_read_b64_tr_b16 a[88:89], v45 offset:16384
    ds_read_b64_tr_b16 a[90:91], v45 offset:18432
    v_mfma_f32_32x32x16_bf16 v[144:159], a[136:139], a[120:123], v[144:159]
    ds_read_b128 a[12:15], v33 offset:0
    ds_read_b128 a[28:31], v33 offset:4096
    buffer_load_dwordx4 v16, s[52:55], s71 offen offset:2048 lds
    v_mfma_f32_32x32x16_bf16 v[160:175], a[152:155], a[104:107], v[160:175]
    ds_read_b64_tr_b16 a[44:45], v42 offset:24576
    ds_read_b64_tr_b16 a[46:47], v42 offset:26624
    v_mfma_f32_32x32x16_bf16 v[176:191], a[152:155], a[120:123], v[176:191]
    ds_read_b64_tr_b16 a[60:61], v43 offset:24576
    ds_read_b64_tr_b16 a[62:63], v43 offset:26624
    v_mfma_f32_32x32x16_bf16 v[192:207], a[168:171], a[104:107], v[192:207]
    ds_read_b64_tr_b16 a[76:77], v44 offset:24576
    ds_read_b64_tr_b16 a[78:79], v44 offset:26624
    buffer_load_dwordx4 v17, s[52:55], s71 offen offset:3072 lds
    v_mfma_f32_32x32x16_bf16 v[208:223], a[168:171], a[120:123], v[208:223]
    ds_read_b64_tr_b16 a[92:93], v45 offset:24576
    ds_read_b64_tr_b16 a[94:95], v45 offset:26624
    v_mfma_f32_32x32x16_bf16 v[224:239], a[184:187], a[104:107], v[224:239]
    s_add_u32 m0, s70, 53248
    s_nop 0
    buffer_load_dwordx4 v18, s[52:55], s71 offen offset:0 lds
    v_mfma_f32_32x32x16_bf16 v[240:255], a[184:187], a[120:123], v[240:255]
    v_mfma_f32_32x32x16_bf16 v[128:143], a[140:143], a[108:111], v[128:143]
    v_mfma_f32_32x32x16_bf16 v[144:159], a[140:143], a[124:127], v[144:159]
    buffer_load_dwordx4 v19, s[52:55], s71 offen offset:1024 lds
    v_mfma_f32_32x32x16_bf16 v[160:175], a[156:159], a[108:111], v[160:175]
    v_mfma_f32_32x32x16_bf16 v[176:191], a[156:159], a[124:127], v[176:191]
    buffer_load_dwordx4 v20, s[52:55], s71 offen offset:2048 lds
    v_mfma_f32_32x32x16_bf16 v[192:207], a[172:175], a[108:111], v[192:207]
    v_mfma_f32_32x32x16_bf16 v[208:223], a[172:175], a[124:127], v[208:223]
    v_mfma_f32_32x32x16_bf16 v[224:239], a[188:191], a[108:111], v[224:239]
    buffer_load_dwordx4 v21, s[52:55], s71 offen offset:3072 lds
    v_mfma_f32_32x32x16_bf16 v[240:255], a[188:191], a[124:127], v[240:255]
    s_waitcnt lgkmcnt(0)
    v_mfma_f32_32x32x16_bf16 v[128:143], a[32:35], a[0:3], v[128:143]
    v_mfma_f32_32x32x16_bf16 v[144:159], a[32:35], a[16:19], v[144:159]
    s_waitcnt vmcnt(12)
    s_barrier
    v_mfma_f32_32x32x16_bf16 v[160:175], a[48:51], a[0:3], v[160:175]
    ds_read_b128 a[96:99], v22 offset:0
    ds_read_b128 a[112:115], v22 offset:4096
    s_add_u32 s68, s68, 128
    s_cmp_eq_u32 s68, 1280
    s_cselect_b32 s68, 0, s68
    s_add_u32 m0, s69, 98304
    s_mul_i32 s71, s68, 1536
    buffer_load_dwordx4 v10, s[48:51], s68 offen offset:0 lds
    v_mfma_f32_32x32x16_bf16 v[176:191], a[48:51], a[16:19], v[176:191]
    ds_read_b64_tr_b16 a[128:129], v34 offset:0
    ds_read_b64_tr_b16 a[130:131], v34 offset:2048
    v_mfma_f32_32x32x16_bf16 v[192:207], a[64:67], a[0:3], v[192:207]
    ds_read_b64_tr_b16 a[144:145], v35 offset:0
    ds_read_b64_tr_b16 a[146:147], v35 offset:2048
    v_mfma_f32_32x32x16_bf16 v[208:223], a[64:67], a[16:19], v[208:223]
    ds_read_b64_tr_b16 a[160:161], v36 offset:0
    ds_read_b64_tr_b16 a[162:163], v36 offset:2048
    buffer_load_dwordx4 v11, s[48:51], s68 offen offset:1024 lds
    v_mfma_f32_32x32x16_bf16 v[224:239], a[80:83], a[0:3], v[224:239]
    ds_read_b64_tr_b16 a[176:177], v37 offset:0
    ds_read_b64_tr_b16 a[178:179], v37 offset:2048
    v_mfma_f32_32x32x16_bf16 v[240:255], a[80:83], a[16:19], v[240:255]
    ds_read_b128 a[100:103], v23 offset:0
    ds_read_b128 a[116:119], v23 offset:4096
    buffer_load_dwordx4 v12, s[48:51], s68 offen offset:2048 lds
    v_mfma_f32_32x32x16_bf16 v[128:143], a[36:39], a[4:7], v[128:143]
    ds_read_b64_tr_b16 a[132:133], v34 offset:8192
    ds_read_b64_tr_b16 a[134:135], v34 offset:10240
    v_mfma_f32_32x32x16_bf16 v[144:159], a[36:39], a[20:23], v[144:159]
    ds_read_b64_tr_b16 a[148:149], v35 offset:8192
    ds_read_b64_tr_b16 a[150:151], v35 offset:10240
    v_mfma_f32_32x32x16_bf16 v[160:175], a[52:55], a[4:7], v[160:175]
    ds_read_b64_tr_b16 a[164:165], v36 offset:8192
    ds_read_b64_tr_b16 a[166:167], v36 offset:10240
    buffer_load_dwordx4 v13, s[48:51], s68 offen offset:3072 lds
    v_mfma_f32_32x32x16_bf16 v[176:191], a[52:55], a[20:23], v[176:191]
    ds_read_b64_tr_b16 a[180:181], v37 offset:8192
    ds_read_b64_tr_b16 a[182:183], v37 offset:10240
    v_mfma_f32_32x32x16_bf16 v[192:207], a[68:71], a[4:7], v[192:207]
    ds_read_b128 a[104:107], v24 offset:0
    ds_read_b128 a[120:123], v24 offset:4096
    s_add_u32 m0, s70, 98304
    s_nop 0
    buffer_load_dwordx4 v14, s[52:55], s71 offen offset:0 lds
    v_mfma_f32_32x32x16_bf16 v[208:223], a[68:71], a[20:23], v[208:223]
    ds_read_b64_tr_b16 a[136:137], v34 offset:16384
    ds_read_b64_tr_b16 a[138:139], v34 offset:18432
    v_mfma_f32_32x32x16_bf16 v[224:239], a[84:87], a[4:7], v[224:239]
    ds_read_b64_tr_b16 a[152:153], v35 offset:16384
    ds_read_b64_tr_b16 a[154:155], v35 offset:18432
    v_mfma_f32_32x32x16_bf16 v[240:255], a[84:87], a[20:23], v[240:255]
    ds_read_b64_tr_b16 a[168:169], v36 offset:16384
    ds_read_b64_tr_b16 a[170:171], v36 offset:18432
    buffer_load_dwordx4 v15, s[52:55], s71 offen offset:1024 lds
    v_mfma_f32_32x32x16_bf16 v[128:143], a[40:43], a[8:11], v[128:143]
    ds_read_b64_tr_b16 a[184:185], v37 offset:16384
    ds_read_b64_tr_b16 a[186:187], v37 offset:18432
    v_mfma_f32_32x32x16_bf16 v[144:159], a[40:43], a[24:27], v[144:159]
    ds_read_b128 a[108:111], v25 offset:0
    ds_read_b128 a[124:127], v25 offset:4096
    buffer_load_dwordx4 v16, s[52:55], s71 offen offset:2048 lds
    v_mfma_f32_32x32x16_bf16 v[160:175], a[56:59], a[8:11], v[160:175]
    ds_read_b64_tr_b16 a[140:141], v34 offset:24576
    ds_read_b64_tr_b16 a[142:143], v34 offset:26624
    v_mfma_f32_32x32x16_bf16 v[176:191], a[56:59], a[24:27], v[176:191]
    ds_read_b64_tr_b16 a[156:157], v35 offset:24576
    ds_read_b64_tr_b16 a[158:159], v35 offset:26624
    v_mfma_f32_32x32x16_bf16 v[192:207], a[72:75], a[8:11], v[192:207]
    ds_read_b64_tr_b16 a[172:173], v36 offset:24576
    ds_read_b64_tr_b16 a[174:175], v36 offset:26624
    buffer_load_dwordx4 v17, s[52:55], s71 offen offset:3072 lds
    v_mfma_f32_32x32x16_bf16 v[208:223], a[72:75], a[24:27], v[208:223]
    ds_read_b64_tr_b16 a[188:189], v37 offset:24576
    ds_read_b64_tr_b16 a[190:191], v37 offset:26624
    v_mfma_f32_32x32x16_bf16 v[224:239], a[88:91], a[8:11], v[224:239]
    s_add_u32 m0, s70, 102400
    s_nop 0
    buffer_load_dwordx4 v18, s[52:55], s71 offen offset:0 lds
    v_mfma_f32_32x32x16_bf16 v[240:255], a[88:91], a[24:27], v[240:255]
    v_mfma_f32_32x32x16_bf16 v[128:143], a[44:47], a[12:15], v[128:143]
    v_mfma_f32_32x32x16_bf16 v[144:159], a[44:47], a[28:31], v[144:159]
    buffer_load_dwordx4 v19, s[52:55], s71 offen offset:1024 lds
    v_mfma_f32_32x32x16_bf16 v[160:175], a[60:63], a[12:15], v[160:175]
    v_mfma_f32_32x32x16_bf16 v[176:191], a[60:63], a[28:31], v[176:191]
    buffer_load_dwordx4 v20, s[52:55], s71 offen offset:2048 lds
    v_mfma_f32_32x32x16_bf16 v[192:207], a[76:79], a[12:15], v[192:207]
    v_mfma_f32_32x32x16_bf16 v[208:223], a[76:79], a[28:31], v[208:223]
    v_mfma_f32_32x32x16_bf16 v[224:239], a[92:95], a[12:15], v[224:239]
    buffer_load_dwordx4 v21, s[52:55], s71 offen offset:3072 lds
    v_mfma_f32_32x32x16_bf16 v[240:255], a[92:95], a[28:31], v[240:255]
    s_waitcnt lgkmcnt(0)
    v_mfma_f32_32x32x16_bf16 v[128:143], a[128:131], a[96:99], v[128:143]
    v_mfma_f32_32x32x16_bf16 v[144:159], a[128:131], a[112:115], v[144:159]
    s_waitcnt vmcnt(12)
    s_barrier
    v_mfma_f32_32x32x16_bf16 v[160:175], a[144:147], a[96:99], v[160:175]
    ds_read_b128 a[0:3], v26 offset:0
    ds_read_b128 a[16:19], v26 offset:4096
    s_add_u32 s68, s68, 128
    s_cmp_eq_u32 s68, 1280
    s_cselect_b32 s68, 0, s68
    s_add_u32 m0, s69, 0
    s_mul_i32 s71, s68, 1536
    buffer_load_dwordx4 v10, s[48:51], s68 offen offset:0 lds
    v_mfma_f32_32x32x16_bf16 v[176:191], a[144:147], a[112:115], v[176:191]
    ds_read_b64_tr_b16 a[32:33], v38 offset:0
    ds_read_b64_tr_b16 a[34:35], v38 offset:2048
    v_mfma_f32_32x32x16_bf16 v[192:207], a[160:163], a[96:99], v[192:207]
    ds_read_b64_tr_b16 a[48:49], v39 offset:0
    ds_read_b64_tr_b16 a[50:51], v39 offset:2048
    v_mfma_f32_32x32x16_bf16 v[208:223], a[160:163], a[112:115], v[208:223]
    ds_read_b64_tr_b16 a[64:65], v40 offset:0
    ds_read_b64_tr_b16 a[66:67], v40 offset:2048
    buffer_load_dwordx4 v11, s[48:51], s68 offen offset:1024 lds
    v_mfma_f32_32x32x16_bf16 v[224:239], a[176:179], a[96:99], v[224:239]
    ds_read_b64_tr_b16 a[80:81], v41 offset:0
    ds_read_b64_tr_b16 a[82:83], v41 offset:2048
    v_mfma_f32_32x32x16_bf16 v[240:255], a[176:179], a[112:115], v[240:255]
    ds_read_b128 a[4:7], v27 offset:0
    ds_read_b128 a[20:23], v27 offset:4096
    buffer_load_dwordx4 v12, s[48:51], s68 offen offset:2048 lds
    v_mfma_f32_32x32x16_bf16 v[128:143], a[132:135], a[100:103], v[128:143]
    ds_read_b64_tr_b16 a[36:37], v38 offset:8192
    ds_read_b64_tr_b16 a[38:39], v38 offset:10240
    v_mfma_f32_32x32x16_bf16 v[144:159], a[132:135], a[116:119], v[144:159]
    ds_read_b64_tr_b16 a[52:53], v39 offset:8192
    ds_read_b64_tr_b16 a[54:55], v39 offset:10240
    v_mfma_f32_32x32x16_bf16 v[160:175], a[148:151], a[100:103], v[160:175]
    ds_read_b64_tr_b16 a[68:69], v40 offset:8192
    ds_read_b64_tr_b16 a[70:71], v40 offset:10240
    buffer_load_dwordx4 v13, s[48:51], s68 offen offset:3072 lds
    v_mfma_f32_32x32x16_bf16 v[176:191], a[148:151], a[116:119], v[176:191]
    ds_read_b64_tr_b16 a[84:85], v41 offset:8192
    ds_read_b64_tr_b16 a[86:87], v41 offset:10240
    v_mfma_f32_32x32x16_bf16 v[192:207], a[164:167], a[100:103], v[192:207]
    ds_read_b128 a[8:11], v28 offset:0
    ds_read_b128 a[24:27], v28 offset:4096
    s_add_u32 m0, s70, 0
    s_nop 0
    buffer_load_dwordx4 v14, s[52:55], s71 offen offset:0 lds
    v_mfma_f32_32x32x16_bf16 v[208:223], a[164:167], a[116:119], v[208:223]
    ds_read_b64_tr_b16 a[40:41], v38 offset:16384
    ds_read_b64_tr_b16 a[42:43], v38 offset:18432
    v_mfma_f32_32x32x16_bf16 v[224:239], a[180:183], a[100:103], v[224:239]
    ds_read_b64_tr_b16 a[56:57], v39 offset:16384
    ds_read_b64_tr_b16 a[58:59], v39 offset:18432
    v_mfma_f32_32x32x16_bf16 v[240:255], a[180:183], a[116:119], v[240:255]
    ds_read_b64_tr_b16 a[72:73], v40 offset:16384
    ds_read_b64_tr_b16 a[74:75], v40 offset:18432
    buffer_load_dwordx4 v15, s[52:55], s71 offen offset:1024 lds
    v_mfma_f32_32x32x16_bf16 v[128:143], a[136:139], a[104:107], v[128:143]
    ds_read_b64_tr_b16 a[88:89], v41 offset:16384
    ds_read_b64_tr_b16 a[90:91], v41 offset:18432
    v_mfma_f32_32x32x16_bf16 v[144:159], a[136:139], a[120:123], v[144:159]
    ds_read_b128 a[12:15], v29 offset:0
    ds_read_b128 a[28:31], v29 offset:4096
    buffer_load_dwordx4 v16, s[52:55], s71 offen offset:2048 lds
    v_mfma_f32_32x32x16_bf16 v[160:175], a[152:155], a[104:107], v[160:175]
    ds_read_b64_tr_b16 a[44:45], v38 offset:24576
    ds_read_b64_tr_b16 a[46:47], v38 offset:26624
    v_mfma_f32_32x32x16_bf16 v[176:191], a[152:155], a[120:123], v[176:191]
    ds_read_b64_tr_b16 a[60:61], v39 offset:24576
    ds_read_b64_tr_b16 a[62:63], v39 offset:26624
    v_mfma_f32_32x32x16_bf16 v[192:207], a[168:171], a[104:107], v[192:207]
    ds_read_b64_tr_b16 a[76:77], v40 offset:24576
    ds_read_b64_tr_b16 a[78:79], v40 offset:26624
    buffer_load_dwordx4 v17, s[52:55], s71 offen offset:3072 lds
    v_mfma_f32_32x32x16_bf16 v[208:223], a[168:171], a[120:123], v[208:223]
    ds_read_b64_tr_b16 a[92:93], v41 offset:24576
    ds_read_b64_tr_b16 a[94:95], v41 offset:26624
    v_mfma_f32_32x32x16_bf16 v[224:239], a[184:187], a[104:107], v[224:239]
    s_add_u32 m0, s70, 4096
    s_nop 0
    buffer_load_dwordx4 v18, s[52:55], s71 offen offset:0 lds
    v_mfma_f32_32x32x16_bf16 v[240:255], a[184:187], a[120:123], v[240:255]
    v_mfma_f32_32x32x16_bf16 v[128:143], a[140:143], a[108:111], v[128:143]
    v_mfma_f32_32x32x16_bf16 v[144:159], a[140:143], a[124:127], v[144:159]
    buffer_load_dwordx4 v19, s[52:55], s71 offen offset:1024 lds
    v_mfma_f32_32x32x16_bf16 v[160:175], a[156:159], a[108:111], v[160:175]
    v_mfma_f32_32x32x16_bf16 v[176:191], a[156:159], a[124:127], v[176:191]
    buffer_load_dwordx4 v20, s[52:55], s71 offen offset:2048 lds
    v_mfma_f32_32x32x16_bf16 v[192:207], a[172:175], a[108:111], v[192:207]
    v_mfma_f32_32x32x16_bf16 v[208:223], a[172:175], a[124:127], v[208:223]
    v_mfma_f32_32x32x16_bf16 v[224:239], a[188:191], a[108:111], v[224:239]
    buffer_load_dwordx4 v21, s[52:55], s71 offen offset:3072 lds
    v_mfma_f32_32x32x16_bf16 v[240:255], a[188:191], a[124:127], v[240:255]
    s_waitcnt lgkmcnt(0)
    v_mfma_f32_32x32x16_bf16 v[128:143], a[32:35], a[0:3], v[128:143]
    v_mfma_f32_32x32x16_bf16 v[144:159], a[32:35], a[16:19], v[144:159]
    s_waitcnt vmcnt(12)
    s_barrier
    v_mfma_f32_32x32x16_bf16 v[160:175], a[48:51], a[0:3], v[160:175]
    ds_read_b128 a[96:99], v30 offset:0
    ds_read_b128 a[112:115], v30 offset:4096
    s_add_u32 s68, s68, 128
    s_cmp_eq_u32 s68, 1280
    s_cselect_b32 s68, 0, s68
    s_add_u32 m0, s69, 49152
    s_mul_i32 s71, s68, 1536
    buffer_load_dwordx4 v10, s[48:51], s68 offen offset:0 lds
    v_mfma_f32_32x32x16_bf16 v[176:191], a[48:51], a[16:19], v[176:191]
    ds_read_b64_tr_b16 a[128:129], v42 offset:0
    ds_read_b64_tr_b16 a[130:131], v42 offset:2048
    v_mfma_f32_32x32x16_bf16 v[192:207], a[64:67], a[0:3], v[192:207]
    ds_read_b64_tr_b16 a[144:145], v43 offset:0
    ds_read_b64_tr_b16 a[146:147], v43 offset:2048
    v_mfma_f32_32x32x16_bf16 v[208:223], a[64:67], a[16:19], v[208:223]
    ds_read_b64_tr_b16 a[160:161], v44 offset:0
    ds_read_b64_tr_b16 a[162:163], v44 offset:2048
    buffer_load_dwordx4 v11, s[48:51], s68 offen offset:1024 lds
    v_mfma_f32_32x32x16_bf16 v[224:239], a[80:83], a[0:3], v[224:239]
    ds_read_b64_tr_b16 a[176:177], v45 offset:0
    ds_read_b64_tr_b16 a[178:179], v45 offset:2048
    v_mfma_f32_32x32x16_bf16 v[240:255], a[80:83], a[16:19], v[240:255]
    ds_read_b128 a[100:103], v31 offset:0
    ds_read_b128 a[116:119], v31 offset:4096
    buffer_load_dwordx4 v12, s[48:51], s68 offen offset:2048 lds
    v_mfma_f32_32x32x16_bf16 v[128:143], a[36:39], a[4:7], v[128:143]
    ds_read_b64_tr_b16 a[132:133], v42 offset:8192
    ds_read_b64_tr_b16 a[134:135], v42 offset:10240
    v_mfma_f32_32x32x16_bf16 v[144:159], a[36:39], a[20:23], v[144:159]
    ds_read_b64_tr_b16 a[148:149], v43 offset:8192
    ds_read_b64_tr_b16 a[150:151], v43 offset:10240
    v_mfma_f32_32x32x16_bf16 v[160:175], a[52:55], a[4:7], v[160:175]
    ds_read_b64_tr_b16 a[164:165], v44 offset:8192
    ds_read_b64_tr_b16 a[166:167], v44 offset:10240
    buffer_load_dwordx4 v13, s[48:51], s68 offen offset:3072 lds
    v_mfma_f32_32x32x16_bf16 v[176:191], a[52:55], a[20:23], v[176:191]
    ds_read_b64_tr_b16 a[180:181], v45 offset:8192
    ds_read_b64_tr_b16 a[182:183], v45 offset:10240
    v_mfma_f32_32x32x16_bf16 v[192:207], a[68:71], a[4:7], v[192:207]
    ds_read_b128 a[104:107], v32 offset:0
    ds_read_b128 a[120:123], v32 offset:4096
    s_add_u32 m0, s70, 49152
    s_nop 0
    buffer_load_dwordx4 v14, s[52:55], s71 offen offset:0 lds
    v_mfma_f32_32x32x16_bf16 v[208:223], a[68:71], a[20:23], v[208:223]
    ds_read_b64_tr_b16 a[136:137], v42 offset:16384
    ds_read_b64_tr_b16 a[138:139], v42 offset:18432
    v_mfma_f32_32x32x16_bf16 v[224:239], a[84:87], a[4:7], v[224:239]
    ds_read_b64_tr_b16 a[152:153], v43 offset:16384
    ds_read_b64_tr_b16 a[154:155], v43 offset:18432
    v_mfma_f32_32x32x16_bf16 v[240:255], a[84:87], a[20:23], v[240:255]
    ds_read_b64_tr_b16 a[168:169], v44 offset:16384
    ds_read_b64_tr_b16 a[170:171], v44 offset:18432
    buffer_load_dwordx4 v15, s[52:55], s71 offen offset:1024 lds
    v_mfma_f32_32x32x16_bf16 v[128:143], a[40:43], a[8:11], v[128:143]
    ds_read_b64_tr_b16 a[184:185], v45 offset:16384
    ds_read_b64_tr_b16 a[186:187], v45 offset:18432
    v_mfma_f32_32x32x16_bf16 v[144:159], a[40:43], a[24:27], v[144:159]
    ds_read_b128 a[108:111], v33 offset:0
    ds_read_b128 a[124:127], v33 offset:4096
    buffer_load_dwordx4 v16, s[52:55], s71 offen offset:2048 lds
    v_mfma_f32_32x32x16_bf16 v[160:175], a[56:59], a[8:11], v[160:175]
    ds_read_b64_tr_b16 a[140:141], v42 offset:24576
    ds_read_b64_tr_b16 a[142:143], v42 offset:26624
    v_mfma_f32_32x32x16_bf16 v[176:191], a[56:59], a[24:27], v[176:191]
    ds_read_b64_tr_b16 a[156:157], v43 offset:24576
    ds_read_b64_tr_b16 a[158:159], v43 offset:26624
    v_mfma_f32_32x32x16_bf16 v[192:207], a[72:75], a[8:11], v[192:207]
    ds_read_b64_tr_b16 a[172:173], v44 offset:24576
    ds_read_b64_tr_b16 a[174:175], v44 offset:26624
    buffer_load_dwordx4 v17, s[52:55], s71 offen offset:3072 lds
    v_mfma_f32_32x32x16_bf16 v[208:223], a[72:75], a[24:27], v[208:223]
    ds_read_b64_tr_b16 a[188:189], v45 offset:24576
    ds_read_b64_tr_b16 a[190:191], v45 offset:26624
    v_mfma_f32_32x32x16_bf16 v[224:239], a[88:91], a[8:11], v[224:239]
    s_add_u32 m0, s70, 53248
    s_nop 0
    buffer_load_dwordx4 v18, s[52:55], s71 offen offset:0 lds
    v_mfma_f32_32x32x16_bf16 v[240:255], a[88:91], a[24:27], v[240:255]
    v_mfma_f32_32x32x16_bf16 v[128:143], a[44:47], a[12:15], v[128:143]
    v_mfma_f32_32x32x16_bf16 v[144:159], a[44:47], a[28:31], v[144:159]
    buffer_load_dwordx4 v19, s[52:55], s71 offen offset:1024 lds
    v_mfma_f32_32x32x16_bf16 v[160:175], a[60:63], a[12:15], v[160:175]
    v_mfma_f32_32x32x16_bf16 v[176:191], a[60:63], a[28:31], v[176:191]
    buffer_load_dwordx4 v20, s[52:55], s71 offen offset:2048 lds
    v_mfma_f32_32x32x16_bf16 v[192:207], a[76:79], a[12:15], v[192:207]
    v_mfma_f32_32x32x16_bf16 v[208:223], a[76:79], a[28:31], v[208:223]
    v_mfma_f32_32x32x16_bf16 v[224:239], a[92:95], a[12:15], v[224:239]
    buffer_load_dwordx4 v21, s[52:55], s71 offen offset:3072 lds
    v_mfma_f32_32x32x16_bf16 v[240:255], a[92:95], a[28:31], v[240:255]
    s_waitcnt lgkmcnt(0)
    v_mfma_f32_32x32x16_bf16 v[128:143], a[128:131], a[96:99], v[128:143]
    v_mfma_f32_32x32x16_bf16 v[144:159], a[128:131], a[112:115], v[144:159]
    s_waitcnt vmcnt(12)
    s_barrier
    v_mfma_f32_32x32x16_bf16 v[160:175], a[144:147], a[96:99], v[160:175]
    ds_read_b128 a[0:3], v22 offset:0
    ds_read_b128 a[16:19], v22 offset:4096
    s_add_u32 s68, s68, 128
    s_cmp_eq_u32 s68, 1280
    s_cselect_b32 s68, 0, s68
    s_add_u32 m0, s69, 98304
    s_mul_i32 s71, s68, 1536
    buffer_load_dwordx4 v10, s[48:51], s68 offen offset:0 lds
    v_mfma_f32_32x32x16_bf16 v[176:191], a[144:147], a[112:115], v[176:191]
    ds_read_b64_tr_b16 a[32:33], v34 offset:0
    ds_read_b64_tr_b16 a[34:35], v34 offset:2048
    v_mfma_f32_32x32x16_bf16 v[192:207], a[160:163], a[96:99], v[192:207]
    ds_read_b64_tr_b16 a[48:49], v35 offset:0
    ds_read_b64_tr_b16 a[50:51], v35 offset:2048
    v_mfma_f32_32x32x16_bf16 v[208:223], a[160:163], a[112:115], v[208:223]
    ds_read_b64_tr_b16 a[64:65], v36 offset:0
    ds_read_b64_tr_b16 a[66:67], v36 offset:2048
    buffer_load_dwordx4 v11, s[48:51], s68 offen offset:1024 lds
    v_mfma_f32_32x32x16_bf16 v[224:239], a[176:179], a[96:99], v[224:239]
    ds_read_b64_tr_b16 a[80:81], v37 offset:0
    ds_read_b64_tr_b16 a[82:83], v37 offset:2048
    v_mfma_f32_32x32x16_bf16 v[240:255], a[176:179], a[112:115], v[240:255]
    ds_read_b128 a[4:7], v23 offset:0
    ds_read_b128 a[20:23], v23 offset:4096
    buffer_load_dwordx4 v12, s[48:51], s68 offen offset:2048 lds
    v_mfma_f32_32x32x16_bf16 v[128:143], a[132:135], a[100:103], v[128:143]
    ds_read_b64_tr_b16 a[36:37], v34 offset:8192
    ds_read_b64_tr_b16 a[38:39], v34 offset:10240
    v_mfma_f32_32x32x16_bf16 v[144:159], a[132:135], a[116:119], v[144:159]
    ds_read_b64_tr_b16 a[52:53], v35 offset:8192
    ds_read_b64_tr_b16 a[54:55], v35 offset:10240
    v_mfma_f32_32x32x16_bf16 v[160:175], a[148:151], a[100:103], v[160:175]
    ds_read_b64_tr_b16 a[68:69], v36 offset:8192
    ds_read_b64_tr_b16 a[70:71], v36 offset:10240
    buffer_load_dwordx4 v13, s[48:51], s68 offen offset:3072 lds
    v_mfma_f32_32x32x16_bf16 v[176:191], a[148:151], a[116:119], v[176:191]
    ds_read_b64_tr_b16 a[84:85], v37 offset:8192
    ds_read_b64_tr_b16 a[86:87], v37 offset:10240
    v_mfma_f32_32x32x16_bf16 v[192:207], a[164:167], a[100:103], v[192:207]
    ds_read_b128 a[8:11], v24 offset:0
    ds_read_b128 a[24:27], v24 offset:4096
    s_add_u32 m0, s70, 98304
    s_nop 0
    buffer_load_dwordx4 v14, s[52:55], s71 offen offset:0 lds
    v_mfma_f32_32x32x16_bf16 v[208:223], a[164:167], a[116:119], v[208:223]
    ds_read_b64_tr_b16 a[40:41], v34 offset:16384
    ds_read_b64_tr_b16 a[42:43], v34 offset:18432
    v_mfma_f32_32x32x16_bf16 v[224:239], a[180:183], a[100:103], v[224:239]
    ds_read_b64_tr_b16 a[56:57], v35 offset:16384
    ds_read_b64_tr_b16 a[58:59], v35 offset:18432
    v_mfma_f32_32x32x16_bf16 v[240:255], a[180:183], a[116:119], v[240:255]
    ds_read_b64_tr_b16 a[72:73], v36 offset:16384
    ds_read_b64_tr_b16 a[74:75], v36 offset:18432
    buffer_load_dwordx4 v15, s[52:55], s71 offen offset:1024 lds
    v_mfma_f32_32x32x16_bf16 v[128:143], a[136:139], a[104:107], v[128:143]
    ds_read_b64_tr_b16 a[88:89], v37 offset:16384
    ds_read_b64_tr_b16 a[90:91], v37 offset:18432
    v_mfma_f32_32x32x16_bf16 v[144:159], a[136:139], a[120:123], v[144:159]
    ds_read_b128 a[12:15], v25 offset:0
    ds_read_b128 a[28:31], v25 offset:4096
    buffer_load_dwordx4 v16, s[52:55], s71 offen offset:2048 lds
    v_mfma_f32_32x32x16_bf16 v[160:175], a[152:155], a[104:107], v[160:175]
    ds_read_b64_tr_b16 a[44:45], v34 offset:24576
    ds_read_b64_tr_b16 a[46:47], v34 offset:26624
    v_mfma_f32_32x32x16_bf16 v[176:191], a[152:155], a[120:123], v[176:191]
    ds_read_b64_tr_b16 a[60:61], v35 offset:24576
    ds_read_b64_tr_b16 a[62:63], v35 offset:26624
    v_mfma_f32_32x32x16_bf16 v[192:207], a[168:171], a[104:107], v[192:207]
    ds_read_b64_tr_b16 a[76:77], v36 offset:24576
    ds_read_b64_tr_b16 a[78:79], v36 offset:26624
    buffer_load_dwordx4 v17, s[52:55], s71 offen offset:3072 lds
    v_mfma_f32_32x32x16_bf16 v[208:223], a[168:171], a[120:123], v[208:223]
    ds_read_b64_tr_b16 a[92:93], v37 offset:24576
    ds_read_b64_tr_b16 a[94:95], v37 offset:26624
    v_mfma_f32_32x32x16_bf16 v[224:239], a[184:187], a[104:107], v[224:239]
    s_add_u32 m0, s70, 102400
    s_nop 0
    buffer_load_dwordx4 v18, s[52:55], s71 offen offset:0 lds
    v_mfma_f32_32x32x16_bf16 v[240:255], a[184:187], a[120:123], v[240:255]
    v_mfma_f32_32x32x16_bf16 v[128:143], a[140:143], a[108:111], v[128:143]
    v_mfma_f32_32x32x16_bf16 v[144:159], a[140:143], a[124:127], v[144:159]
    buffer_load_dwordx4 v19, s[52:55], s71 offen offset:1024 lds
    v_mfma_f32_32x32x16_bf16 v[160:175], a[156:159], a[108:111], v[160:175]
    v_mfma_f32_32x32x16_bf16 v[176:191], a[156:159], a[124:127], v[176:191]
    buffer_load_dwordx4 v20, s[52:55], s71 offen offset:2048 lds
    v_mfma_f32_32x32x16_bf16 v[192:207], a[172:175], a[108:111], v[192:207]
    v_mfma_f32_32x32x16_bf16 v[208:223], a[172:175], a[124:127], v[208:223]
    v_mfma_f32_32x32x16_bf16 v[224:239], a[188:191], a[108:111], v[224:239]
    buffer_load_dwordx4 v21, s[52:55], s71 offen offset:3072 lds
    v_mfma_f32_32x32x16_bf16 v[240:255], a[188:191], a[124:127], v[240:255]
    s_waitcnt lgkmcnt(0)
    v_mfma_f32_32x32x16_bf16 v[128:143], a[32:35], a[0:3], v[128:143]
    v_mfma_f32_32x32x16_bf16 v[144:159], a[32:35], a[16:19], v[144:159]
    s_waitcnt vmcnt(12)
    s_barrier
    v_mfma_f32_32x32x16_bf16 v[160:175], a[48:51], a[0:3], v[160:175]
    ds_read_b128 a[96:99], v26 offset:0
    ds_read_b128 a[112:115], v26 offset:4096
    s_add_u32 s68, s68, 128
    s_cmp_eq_u32 s68, 1280
    s_cselect_b32 s68, 0, s68
    s_add_u32 m0, s69, 0
    s_mul_i32 s71, s68, 1536
    buffer_load_dwordx4 v10, s[48:51], s68 offen offset:0 lds
    v_mfma_f32_32x32x16_bf16 v[176:191], a[48:51], a[16:19], v[176:191]
    ds_read_b64_tr_b16 a[128:129], v38 offset:0
    ds_read_b64_tr_b16 a[130:131], v38 offset:2048
    v_mfma_f32_32x32x16_bf16 v[192:207], a[64:67], a[0:3], v[192:207]
    ds_read_b64_tr_b16 a[144:145], v39 offset:0
    ds_read_b64_tr_b16 a[146:147], v39 offset:2048
    v_mfma_f32_32x32x16_bf16 v[208:223], a[64:67], a[16:19], v[208:223]
    ds_read_b64_tr_b16 a[160:161], v40 offset:0
    ds_read_b64_tr_b16 a[162:163], v40 offset:2048
    buffer_load_dwordx4 v11, s[48:51], s68 offen offset:1024 lds
    v_mfma_f32_32x32x16_bf16 v[224:239], a[80:83], a[0:3], v[224:239]
    ds_read_b64_tr_b16 a[176:177], v41 offset:0
    ds_read_b64_tr_b16 a[178:179], v41 offset:2048
    v_mfma_f32_32x32x16_bf16 v[240:255], a[80:83], a[16:19], v[240:255]
    ds_read_b128 a[100:103], v27 offset:0
    ds_read_b128 a[116:119], v27 offset:4096
    buffer_load_dwordx4 v12, s[48:51], s68 offen offset:2048 lds
    v_mfma_f32_32x32x16_bf16 v[128:143], a[36:39], a[4:7], v[128:143]
    ds_read_b64_tr_b16 a[132:133], v38 offset:8192
    ds_read_b64_tr_b16 a[134:135], v38 offset:10240
    v_mfma_f32_32x32x16_bf16 v[144:159], a[36:39], a[20:23], v[144:159]
    ds_read_b64_tr_b16 a[148:149], v39 offset:8192
    ds_read_b64_tr_b16 a[150:151], v39 offset:10240
    v_mfma_f32_32x32x16_bf16 v[160:175], a[52:55], a[4:7], v[160:175]
    ds_read_b64_tr_b16 a[164:165], v40 offset:8192
    ds_read_b64_tr_b16 a[166:167], v40 offset:10240
    buffer_load_dwordx4 v13, s[48:51], s68 offen offset:3072 lds
    v_mfma_f32_32x32x16_bf16 v[176:191], a[52:55], a[20:23], v[176:191]
    ds_read_b64_tr_b16 a[180:181], v41 offset:8192
    ds_read_b64_tr_b16 a[182:183], v41 offset:10240
    v_mfma_f32_32x32x16_bf16 v[192:207], a[68:71], a[4:7], v[192:207]
    ds_read_b128 a[104:107], v28 offset:0
    ds_read_b128 a[120:123], v28 offset:4096
    s_add_u32 m0, s70, 0
    s_nop 0
    buffer_load_dwordx4 v14, s[52:55], s71 offen offset:0 lds
    v_mfma_f32_32x32x16_bf16 v[208:223], a[68:71], a[20:23], v[208:223]
    ds_read_b64_tr_b16 a[136:137], v38 offset:16384
    ds_read_b64_tr_b16 a[138:139], v38 offset:18432
    v_mfma_f32_32x32x16_bf16 v[224:239], a[84:87], a[4:7], v[224:239]
    ds_read_b64_tr_b16 a[152:153], v39 offset:16384
    ds_read_b64_tr_b16 a[154:155], v39 offset:18432
    v_mfma_f32_32x32x16_bf16 v[240:255], a[84:87], a[20:23], v[240:255]
    ds_read_b64_tr_b16 a[168:169], v40 offset:16384
    ds_read_b64_tr_b16 a[170:171], v40 offset:18432
    buffer_load_dwordx4 v15, s[52:55], s71 offen offset:1024 lds
    v_mfma_f32_32x32x16_bf16 v[128:143], a[40:43], a[8:11], v[128:143]
    ds_read_b64_tr_b16 a[184:185], v41 offset:16384
    ds_read_b64_tr_b16 a[186:187], v41 offset:18432
    v_mfma_f32_32x32x16_bf16 v[144:159], a[40:43], a[24:27], v[144:159]
    ds_read_b128 a[108:111], v29 offset:0
    ds_read_b128 a[124:127], v29 offset:4096
    buffer_load_dwordx4 v16, s[52:55], s71 offen offset:2048 lds
    v_mfma_f32_32x32x16_bf16 v[160:175], a[56:59], a[8:11], v[160:175]
    ds_read_b64_tr_b16 a[140:141], v38 offset:24576
    ds_read_b64_tr_b16 a[142:143], v38 offset:26624
    v_mfma_f32_32x32x16_bf16 v[176:191], a[56:59], a[24:27], v[176:191]
    ds_read_b64_tr_b16 a[156:157], v39 offset:24576
    ds_read_b64_tr_b16 a[158:159], v39 offset:26624
    v_mfma_f32_32x32x16_bf16 v[192:207], a[72:75], a[8:11], v[192:207]
    ds_read_b64_tr_b16 a[172:173], v40 offset:24576
    ds_read_b64_tr_b16 a[174:175], v40 offset:26624
    buffer_load_dwordx4 v17, s[52:55], s71 offen offset:3072 lds
    v_mfma_f32_32x32x16_bf16 v[208:223], a[72:75], a[24:27], v[208:223]
    ds_read_b64_tr_b16 a[188:189], v41 offset:24576
    ds_read_b64_tr_b16 a[190:191], v41 offset:26624
    v_mfma_f32_32x32x16_bf16 v[224:239], a[88:91], a[8:11], v[224:239]
    s_add_u32 m0, s70, 4096
    s_nop 0
    buffer_load_dwordx4 v18, s[52:55], s71 offen offset:0 lds
    v_mfma_f32_32x32x16_bf16 v[240:255], a[88:91], a[24:27], v[240:255]
    v_mfma_f32_32x32x16_bf16 v[128:143], a[44:47], a[12:15], v[128:143]
    v_mfma_f32_32x32x16_bf16 v[144:159], a[44:47], a[28:31], v[144:159]
    buffer_load_dwordx4 v19, s[52:55], s71 offen offset:1024 lds
    v_mfma_f32_32x32x16_bf16 v[160:175], a[60:63], a[12:15], v[160:175]
    v_mfma_f32_32x32x16_bf16 v[176:191], a[60:63], a[28:31], v[176:191]
    buffer_load_dwordx4 v20, s[52:55], s71 offen offset:2048 lds
    v_mfma_f32_32x32x16_bf16 v[192:207], a[76:79], a[12:15], v[192:207]
    v_mfma_f32_32x32x16_bf16 v[208:223], a[76:79], a[28:31], v[208:223]
    v_mfma_f32_32x32x16_bf16 v[224:239], a[92:95], a[12:15], v[224:239]
    buffer_load_dwordx4 v21, s[52:55], s71 offen offset:3072 lds
    v_mfma_f32_32x32x16_bf16 v[240:255], a[92:95], a[28:31], v[240:255]
    s_waitcnt lgkmcnt(0)
    v_mfma_f32_32x32x16_bf16 v[128:143], a[128:131], a[96:99], v[128:143]
    v_mfma_f32_32x32x16_bf16 v[144:159], a[128:131], a[112:115], v[144:159]
    s_waitcnt vmcnt(12)
    s_barrier
    v_mfma_f32_32x32x16_bf16 v[160:175], a[144:147], a[96:99], v[160:175]
    ds_read_b128 a[0:3], v30 offset:0
    ds_read_b128 a[16:19], v30 offset:4096
    v_mfma_f32_32x32x16_bf16 v[176:191], a[144:147], a[112:115], v[176:191]
    ds_read_b64_tr_b16 a[32:33], v42 offset:0
    ds_read_b64_tr_b16 a[34:35], v42 offset:2048
    v_mfma_f32_32x32x16_bf16 v[192:207], a[160:163], a[96:99], v[192:207]
    ds_read_b64_tr_b16 a[48:49], v43 offset:0
    ds_read_b64_tr_b16 a[50:51], v43 offset:2048
    v_mfma_f32_32x32x16_bf16 v[208:223], a[160:163], a[112:115], v[208:223]
    ds_read_b64_tr_b16 a[64:65], v44 offset:0
    ds_read_b64_tr_b16 a[66:67], v44 offset:2048
    v_mfma_f32_32x32x16_bf16 v[224:239], a[176:179], a[96:99], v[224:239]
    ds_read_b64_tr_b16 a[80:81], v45 offset:0
    ds_read_b64_tr_b16 a[82:83], v45 offset:2048
    v_mfma_f32_32x32x16_bf16 v[240:255], a[176:179], a[112:115], v[240:255]
    ds_read_b128 a[4:7], v31 offset:0
    ds_read_b128 a[20:23], v31 offset:4096
    v_mfma_f32_32x32x16_bf16 v[128:143], a[132:135], a[100:103], v[128:143]
    ds_read_b64_tr_b16 a[36:37], v42 offset:8192
    ds_read_b64_tr_b16 a[38:39], v42 offset:10240
    v_mfma_f32_32x32x16_bf16 v[144:159], a[132:135], a[116:119], v[144:159]
    ds_read_b64_tr_b16 a[52:53], v43 offset:8192
    ds_read_b64_tr_b16 a[54:55], v43 offset:10240
    v_mfma_f32_32x32x16_bf16 v[160:175], a[148:151], a[100:103], v[160:175]
    ds_read_b64_tr_b16 a[68:69], v44 offset:8192
    ds_read_b64_tr_b16 a[70:71], v44 offset:10240
    v_mfma_f32_32x32x16_bf16 v[176:191], a[148:151], a[116:119], v[176:191]
    ds_read_b64_tr_b16 a[84:85], v45 offset:8192
    ds_read_b64_tr_b16 a[86:87], v45 offset:10240
    v_mfma_f32_32x32x16_bf16 v[192:207], a[164:167], a[100:103], v[192:207]
    ds_read_b128 a[8:11], v32 offset:0
    ds_read_b128 a[24:27], v32 offset:4096
    v_mfma_f32_32x32x16_bf16 v[208:223], a[164:167], a[116:119], v[208:223]
    ds_read_b64_tr_b16 a[40:41], v42 offset:16384
    ds_read_b64_tr_b16 a[42:43], v42 offset:18432
    v_mfma_f32_32x32x16_bf16 v[224:239], a[180:183], a[100:103], v[224:239]
    ds_read_b64_tr_b16 a[56:57], v43 offset:16384
    ds_read_b64_tr_b16 a[58:59], v43 offset:18432
    v_mfma_f32_32x32x16_bf16 v[240:255], a[180:183], a[116:119], v[240:255]
    ds_read_b64_tr_b16 a[72:73], v44 offset:16384
    ds_read_b64_tr_b16 a[74:75], v44 offset:18432
    v_mfma_f32_32x32x16_bf16 v[128:143], a[136:139], a[104:107], v[128:143]
    ds_read_b64_tr_b16 a[88:89], v45 offset:16384
    ds_read_b64_tr_b16 a[90:91], v45 offset:18432
    v_mfma_f32_32x32x16_bf16 v[144:159], a[136:139], a[120:123], v[144:159]
    ds_read_b128 a[12:15], v33 offset:0
    ds_read_b128 a[28:31], v33 offset:4096
    v_mfma_f32_32x32x16_bf16 v[160:175], a[152:155], a[104:107], v[160:175]
    ds_read_b64_tr_b16 a[44:45], v42 offset:24576
    ds_read_b64_tr_b16 a[46:47], v42 offset:26624
    v_mfma_f32_32x32x16_bf16 v[176:191], a[152:155], a[120:123], v[176:191]
    ds_read_b64_tr_b16 a[60:61], v43 offset:24576
    ds_read_b64_tr_b16 a[62:63], v43 offset:26624
    v_mfma_f32_32x32x16_bf16 v[192:207], a[168:171], a[104:107], v[192:207]
    ds_read_b64_tr_b16 a[76:77], v44 offset:24576
    ds_read_b64_tr_b16 a[78:79], v44 offset:26624
    v_mfma_f32_32x32x16_bf16 v[208:223], a[168:171], a[120:123], v[208:223]
    ds_read_b64_tr_b16 a[92:93], v45 offset:24576
    ds_read_b64_tr_b16 a[94:95], v45 offset:26624
    v_mfma_f32_32x32x16_bf16 v[224:239], a[184:187], a[104:107], v[224:239]
    v_mfma_f32_32x32x16_bf16 v[240:255], a[184:187], a[120:123], v[240:255]
    v_mfma_f32_32x32x16_bf16 v[128:143], a[140:143], a[108:111], v[128:143]
    v_mfma_f32_32x32x16_bf16 v[144:159], a[140:143], a[124:127], v[144:159]
    v_mfma_f32_32x32x16_bf16 v[160:175], a[156:159], a[108:111], v[160:175]
    v_mfma_f32_32x32x16_bf16 v[176:191], a[156:159], a[124:127], v[176:191]
    v_mfma_f32_32x32x16_bf16 v[192:207], a[172:175], a[108:111], v[192:207]
    v_mfma_f32_32x32x16_bf16 v[208:223], a[172:175], a[124:127], v[208:223]
    v_mfma_f32_32x32x16_bf16 v[224:239], a[188:191], a[108:111], v[224:239]
    v_mfma_f32_32x32x16_bf16 v[240:255], a[188:191], a[124:127], v[240:255]
    s_waitcnt lgkmcnt(0)
    v_mfma_f32_32x32x16_bf16 v[128:143], a[32:35], a[0:3], v[128:143]
    v_mfma_f32_32x32x16_bf16 v[144:159], a[32:35], a[16:19], v[144:159]
    s_waitcnt vmcnt(0)
    s_barrier
    v_mfma_f32_32x32x16_bf16 v[160:175], a[48:51], a[0:3], v[160:175]
    ds_read_b128 a[96:99], v22 offset:0
    ds_read_b128 a[112:115], v22 offset:4096
    s_cmp_lg_u32 s38, 0
    s_cbranch_scc1 L_nl_46_1028
    v_mov_b32 v47, 0
    global_load_dword v46, v47, s[32:33] sc0 sc1
L_nl_46_1028:
    v_mfma_f32_32x32x16_bf16 v[176:191], a[48:51], a[16:19], v[176:191]
    ds_read_b64_tr_b16 a[128:129], v34 offset:0
    ds_read_b64_tr_b16 a[130:131], v34 offset:2048
    v_mfma_f32_32x32x16_bf16 v[192:207], a[64:67], a[0:3], v[192:207]
    ds_read_b64_tr_b16 a[144:145], v35 offset:0
    ds_read_b64_tr_b16 a[146:147], v35 offset:2048
    v_mfma_f32_32x32x16_bf16 v[208:223], a[64:67], a[16:19], v[208:223]
    ds_read_b64_tr_b16 a[160:161], v36 offset:0
    ds_read_b64_tr_b16 a[162:163], v36 offset:2048
    v_mfma_f32_32x32x16_bf16 v[224:239], a[80:83], a[0:3], v[224:239]
    ds_read_b64_tr_b16 a[176:177], v37 offset:0
    ds_read_b64_tr_b16 a[178:179], v37 offset:2048
    v_mfma_f32_32x32x16_bf16 v[240:255], a[80:83], a[16:19], v[240:255]
    ds_read_b128 a[100:103], v23 offset:0
    ds_read_b128 a[116:119], v23 offset:4096
    v_mfma_f32_32x32x16_bf16 v[128:143], a[36:39], a[4:7], v[128:143]
    ds_read_b64_tr_b16 a[132:133], v34 offset:8192
    ds_read_b64_tr_b16 a[134:135], v34 offset:10240
    v_mfma_f32_32x32x16_bf16 v[144:159], a[36:39], a[20:23], v[144:159]
    ds_read_b64_tr_b16 a[148:149], v35 offset:8192
    ds_read_b64_tr_b16 a[150:151], v35 offset:10240
    v_mfma_f32_32x32x16_bf16 v[160:175], a[52:55], a[4:7], v[160:175]
    ds_read_b64_tr_b16 a[164:165], v36 offset:8192
    ds_read_b64_tr_b16 a[166:167], v36 offset:10240
    v_mfma_f32_32x32x16_bf16 v[176:191], a[52:55], a[20:23], v[176:191]
    ds_read_b64_tr_b16 a[180:181], v37 offset:8192
    ds_read_b64_tr_b16 a[182:183], v37 offset:10240
    v_mfma_f32_32x32x16_bf16 v[192:207], a[68:71], a[4:7], v[192:207]
    ds_read_b128 a[104:107], v24 offset:0
    ds_read_b128 a[120:123], v24 offset:4096
    v_mfma_f32_32x32x16_bf16 v[208:223], a[68:71], a[20:23], v[208:223]
    ds_read_b64_tr_b16 a[136:137], v34 offset:16384
    ds_read_b64_tr_b16 a[138:139], v34 offset:18432
    v_mfma_f32_32x32x16_bf16 v[224:239], a[84:87], a[4:7], v[224:239]
    ds_read_b64_tr_b16 a[152:153], v35 offset:16384
    ds_read_b64_tr_b16 a[154:155], v35 offset:18432
    v_mfma_f32_32x32x16_bf16 v[240:255], a[84:87], a[20:23], v[240:255]
    ds_read_b64_tr_b16 a[168:169], v36 offset:16384
    ds_read_b64_tr_b16 a[170:171], v36 offset:18432
    v_mfma_f32_32x32x16_bf16 v[128:143], a[40:43], a[8:11], v[128:143]
    ds_read_b64_tr_b16 a[184:185], v37 offset:16384
    ds_read_b64_tr_b16 a[186:187], v37 offset:18432
    v_mfma_f32_32x32x16_bf16 v[144:159], a[40:43], a[24:27], v[144:159]
    ds_read_b128 a[108:111], v25 offset:0
    ds_read_b128 a[124:127], v25 offset:4096
    v_mfma_f32_32x32x16_bf16 v[160:175], a[56:59], a[8:11], v[160:175]
    ds_read_b64_tr_b16 a[140:141], v34 offset:24576
    ds_read_b64_tr_b16 a[142:143], v34 offset:26624
    v_mfma_f32_32x32x16_bf16 v[176:191], a[56:59], a[24:27], v[176:191]
    ds_read_b64_tr_b16 a[156:157], v35 offset:24576
    ds_read_b64_tr_b16 a[158:159], v35 offset:26624
    v_mfma_f32_32x32x16_bf16 v[192:207], a[72:75], a[8:11], v[192:207]
    ds_read_b64_tr_b16 a[172:173], v36 offset:24576
    ds_read_b64_tr_b16 a[174:175], v36 offset:26624
    v_mfma_f32_32x32x16_bf16 v[208:223], a[72:75], a[24:27], v[208:223]
    ds_read_b64_tr_b16 a[188:189], v37 offset:24576
    ds_read_b64_tr_b16 a[190:191], v37 offset:26624
    v_mfma_f32_32x32x16_bf16 v[224:239], a[88:91], a[8:11], v[224:239]
    v_mfma_f32_32x32x16_bf16 v[240:255], a[88:91], a[24:27], v[240:255]
    v_mfma_f32_32x32x16_bf16 v[128:143], a[44:47], a[12:15], v[128:143]
    v_mfma_f32_32x32x16_bf16 v[144:159], a[44:47], a[28:31], v[144:159]
    v_mfma_f32_32x32x16_bf16 v[160:175], a[60:63], a[12:15], v[160:175]
    v_mfma_f32_32x32x16_bf16 v[176:191], a[60:63], a[28:31], v[176:191]
    v_mfma_f32_32x32x16_bf16 v[192:207], a[76:79], a[12:15], v[192:207]
    v_mfma_f32_32x32x16_bf16 v[208:223], a[76:79], a[28:31], v[208:223]
    v_mfma_f32_32x32x16_bf16 v[224:239], a[92:95], a[12:15], v[224:239]
    v_mfma_f32_32x32x16_bf16 v[240:255], a[92:95], a[28:31], v[240:255]
    s_waitcnt lgkmcnt(0)
    s_mul_i32 s41, s38, 22
    s_mul_i32 s42, s23, 88
    s_add_u32 s42, s42, s41
    s_mul_i32 s42, s42, 5120
    s_add_u32 s42, s42, 11534336
    s_add_u32 s52, s34, s42
    s_addc_u32 s53, s35, 0
    s_mov_b32 s54, 112640
    s_mov_b32 s55, 0x20000
    v_bfe_u32 v2, v1, 4, 1
    v_lshlrev_b32 v2, 10, v2
    v_lshrrev_b32 v3, 5, v1
    v_lshl_add_u32 v2, v3, 8, v2
    v_and_b32 v3, 15, v1
    v_lshl_add_u32 v2, v3, 4, v2
    s_lshl_b32 s41, s36, 1
    s_add_u32 s41, s41, s39
    s_mul_i32 s41, s41, 88
    s_lshl_b32 s42, s37, 3
    s_add_u32 s41, s41, s42
    s_lshl_b32 s42, s40, 2
    s_add_u32 s41, s41, s42
    s_add_u32 s41, s41, 40
    s_lshl_b32 s41, s41, 12
    s_add_u32 s74, s41, 0
    s_add_u32 s75, s41, 4096
    s_add_u32 s76, s41, 8192
    s_add_u32 s77, s41, 12288
    v_mfma_f32_32x32x16_bf16 v[128:143], a[128:131], a[96:99], v[128:143]
    v_mfma_f32_32x32x16_bf16 v[128:143], a[132:135], a[100:103], v[128:143]
    v_mfma_f32_32x32x16_bf16 v[128:143], a[136:139], a[104:107], v[128:143]
    v_mfma_f32_32x32x16_bf16 v[128:143], a[140:143], a[108:111], v[128:143]
    v_mfma_f32_32x32x16_bf16 v[144:159], a[128:131], a[112:115], v[144:159]
    v_mfma_f32_32x32x16_bf16 v[144:159], a[132:135], a[116:119], v[144:159]
    v_mfma_f32_32x32x16_bf16 v[144:159], a[136:139], a[120:123], v[144:159]
    v_mfma_f32_32x32x16_bf16 v[144:159], a[140:143], a[124:127], v[144:159]
    v_mfma_f32_32x32x16_bf16 v[160:175], a[144:147], a[96:99], v[160:175]
    s_nop 7
    v_cvt_pk_bf16_f32 v64, v128, v129
    v_cvt_pk_bf16_f32 v65, v130, v131
    v_cvt_pk_bf16_f32 v66, v132, v133
    v_cvt_pk_bf16_f32 v67, v134, v135
    v_pk_max_i16 v64, v64, 0
    v_mfma_f32_32x32x16_bf16 v[160:175], a[148:151], a[100:103], v[160:175]
    v_pk_max_i16 v65, v65, 0
    v_pk_max_i16 v66, v66, 0
    v_pk_max_i16 v67, v67, 0
    buffer_store_dwordx4 v[64:67], v2, s[56:59], s74 offen offset:0 sc1
    v_cvt_pk_bf16_f32 v68, v136, v137
    v_mfma_f32_32x32x16_bf16 v[160:175], a[152:155], a[104:107], v[160:175]
    v_cvt_pk_bf16_f32 v69, v138, v139
    v_cvt_pk_bf16_f32 v70, v140, v141
    v_cvt_pk_bf16_f32 v71, v142, v143
    v_pk_max_i16 v68, v68, 0
    v_mfma_f32_32x32x16_bf16 v[160:175], a[156:159], a[108:111], v[160:175]
    v_pk_max_i16 v69, v69, 0
    v_pk_max_i16 v70, v70, 0
    v_pk_max_i16 v71, v71, 0
    buffer_store_dwordx4 v[68:71], v2, s[56:59], s74 offen offset:512 sc1
    v_mfma_f32_32x32x16_bf16 v[176:191], a[144:147], a[112:115], v[176:191]
    v_cvt_pk_bf16_f32 v72, v144, v145
    v_cvt_pk_bf16_f32 v73, v146, v147
    v_cvt_pk_bf16_f32 v74, v148, v149
    v_cvt_pk_bf16_f32 v75, v150, v151
    v_pk_max_i16 v72, v72, 0
    v_mfma_f32_32x32x16_bf16 v[176:191], a[148:151], a[116:119], v[176:191]
    v_pk_max_i16 v73, v73, 0
    v_pk_max_i16 v74, v74, 0
    v_pk_max_i16 v75, v75, 0
    buffer_store_dwordx4 v[72:75], v2, s[56:59], s74 offen offset:2048 sc1
    v_cvt_pk_bf16_f32 v76, v152, v153
    v_mfma_f32_32x32x16_bf16 v[176:191], a[152:155], a[120:123], v[176:191]
    v_cvt_pk_bf16_f32 v77, v154, v155
    v_cvt_pk_bf16_f32 v78, v156, v157
    v_cvt_pk_bf16_f32 v79, v158, v159
    v_pk_max_i16 v76, v76, 0
    v_mfma_f32_32x32x16_bf16 v[176:191], a[156:159], a[124:127], v[176:191]
    v_pk_max_i16 v77, v77, 0
    v_pk_max_i16 v78, v78, 0
    v_pk_max_i16 v79, v79, 0
    buffer_store_dwordx4 v[76:79], v2, s[56:59], s74 offen offset:2560 sc1
    v_mfma_f32_32x32x16_bf16 v[192:207], a[160:163], a[96:99], v[192:207]
    v_cvt_pk_bf16_f32 v80, v160, v161
    v_cvt_pk_bf16_f32 v81, v162, v163
    v_cvt_pk_bf16_f32 v82, v164, v165
    v_cvt_pk_bf16_f32 v83, v166, v167
    v_pk_max_i16 v80, v80, 0
    v_mfma_f32_32x32x16_bf16 v[192:207], a[164:167], a[100:103], v[192:207]
    v_pk_max_i16 v81, v81, 0
    v_pk_max_i16 v82, v82, 0
    v_pk_max_i16 v83, v83, 0
    buffer_store_dwordx4 v[80:83], v2, s[56:59], s75 offen offset:0 sc1
    v_cvt_pk_bf16_f32 v84, v168, v169
    v_mfma_f32_32x32x16_bf16 v[192:207], a[168:171], a[104:107], v[192:207]
    v_cvt_pk_bf16_f32 v85, v170, v171
    v_cvt_pk_bf16_f32 v86, v172, v173
    v_cvt_pk_bf16_f32 v87, v174, v175
    v_pk_max_i16 v84, v84, 0
    v_mfma_f32_32x32x16_bf16 v[192:207], a[172:175], a[108:111], v[192:207]
    v_pk_max_i16 v85, v85, 0
    v_pk_max_i16 v86, v86, 0
    v_pk_max_i16 v87, v87, 0
    buffer_store_dwordx4 v[84:87], v2, s[56:59], s75 offen offset:512 sc1
    v_mfma_f32_32x32x16_bf16 v[208:223], a[160:163], a[112:115], v[208:223]
    v_cvt_pk_bf16_f32 v88, v176, v177
    v_cvt_pk_bf16_f32 v89, v178, v179
    v_cvt_pk_bf16_f32 v90, v180, v181
    v_cvt_pk_bf16_f32 v91, v182, v183
    v_pk_max_i16 v88, v88, 0
    v_mfma_f32_32x32x16_bf16 v[208:223], a[164:167], a[116:119], v[208:223]
    v_pk_max_i16 v89, v89, 0
    v_pk_max_i16 v90, v90, 0
    v_pk_max_i16 v91, v91, 0
    buffer_store_dwordx4 v[88:91], v2, s[56:59], s75 offen offset:2048 sc1
    v_cvt_pk_bf16_f32 v92, v184, v185
    v_mfma_f32_32x32x16_bf16 v[208:223], a[168:171], a[120:123], v[208:223]
    v_cvt_pk_bf16_f32 v93, v186, v187
    v_cvt_pk_bf16_f32 v94, v188, v189
    v_cvt_pk_bf16_f32 v95, v190, v191
    v_pk_max_i16 v92, v92, 0
    v_mfma_f32_32x32x16_bf16 v[208:223], a[172:175], a[124:127], v[208:223]
    v_pk_max_i16 v93, v93, 0
    v_pk_max_i16 v94, v94, 0
    v_pk_max_i16 v95, v95, 0
    buffer_store_dwordx4 v[92:95], v2, s[56:59], s75 offen offset:2560 sc1
    v_mfma_f32_32x32x16_bf16 v[224:239], a[176:179], a[96:99], v[224:239]
    v_cvt_pk_bf16_f32 v64, v192, v193
    v_cvt_pk_bf16_f32 v65, v194, v195
    v_cvt_pk_bf16_f32 v66, v196, v197
    v_cvt_pk_bf16_f32 v67, v198, v199
    v_pk_max_i16 v64, v64, 0
    v_mfma_f32_32x32x16_bf16 v[224:239], a[180:183], a[100:103], v[224:239]
    v_pk_max_i16 v65, v65, 0
    v_pk_max_i16 v66, v66, 0
    v_pk_max_i16 v67, v67, 0
    buffer_store_dwordx4 v[64:67], v2, s[56:59], s76 offen offset:0 sc1
    v_cvt_pk_bf16_f32 v68, v200, v201
    v_mfma_f32_32x32x16_bf16 v[224:239], a[184:187], a[104:107], v[224:239]
    v_cvt_pk_bf16_f32 v69, v202, v203
    v_cvt_pk_bf16_f32 v70, v204, v205
    v_cvt_pk_bf16_f32 v71, v206, v207
    v_pk_max_i16 v68, v68, 0
    v_mfma_f32_32x32x16_bf16 v[224:239], a[188:191], a[108:111], v[224:239]
    v_pk_max_i16 v69, v69, 0
    v_pk_max_i16 v70, v70, 0
    v_pk_max_i16 v71, v71, 0
    buffer_store_dwordx4 v[68:71], v2, s[56:59], s76 offen offset:512 sc1
    v_mfma_f32_32x32x16_bf16 v[240:255], a[176:179], a[112:115], v[240:255]
    v_cvt_pk_bf16_f32 v72, v208, v209
    v_cvt_pk_bf16_f32 v73, v210, v211
    v_cvt_pk_bf16_f32 v74, v212, v213
    v_cvt_pk_bf16_f32 v75, v214, v215
    v_pk_max_i16 v72, v72, 0
    v_mfma_f32_32x32x16_bf16 v[240:255], a[180:183], a[116:119], v[240:255]
    v_pk_max_i16 v73, v73, 0
    v_pk_max_i16 v74, v74, 0
    v_pk_max_i16 v75, v75, 0
    buffer_store_dwordx4 v[72:75], v2, s[56:59], s76 offen offset:2048 sc1
    v_cvt_pk_bf16_f32 v76, v216, v217
    v_mfma_f32_32x32x16_bf16 v[240:255], a[184:187], a[120:123], v[240:255]
    v_cvt_pk_bf16_f32 v77, v218, v219
    v_cvt_pk_bf16_f32 v78, v220, v221
    v_cvt_pk_bf16_f32 v79, v222, v223
    v_pk_max_i16 v76, v76, 0
    v_mfma_f32_32x32x16_bf16 v[240:255], a[188:191], a[124:127], v[240:255]
    v_pk_max_i16 v77, v77, 0
    v_pk_max_i16 v78, v78, 0
    v_pk_max_i16 v79, v79, 0
    buffer_store_dwordx4 v[76:79], v2, s[56:59], s76 offen offset:2560 sc1
    v_cvt_pk_bf16_f32 v80, v224, v225
    v_cvt_pk_bf16_f32 v81, v226, v227
    v_cvt_pk_bf16_f32 v82, v228, v229
    v_cvt_pk_bf16_f32 v83, v230, v231
    v_pk_max_i16 v80, v80, 0
    v_pk_max_i16 v81, v81, 0
    v_pk_max_i16 v82, v82, 0
    v_pk_max_i16 v83, v83, 0
    buffer_store_dwordx4 v[80:83], v2, s[56:59], s77 offen offset:0 sc1
    v_cvt_pk_bf16_f32 v84, v232, v233
    v_cvt_pk_bf16_f32 v85, v234, v235
    v_cvt_pk_bf16_f32 v86, v236, v237
    v_cvt_pk_bf16_f32 v87, v238, v239
    v_pk_max_i16 v84, v84, 0
    v_pk_max_i16 v85, v85, 0
    v_pk_max_i16 v86, v86, 0
    v_pk_max_i16 v87, v87, 0
    buffer_store_dwordx4 v[84:87], v2, s[56:59], s77 offen offset:512 sc1
    v_cvt_pk_bf16_f32 v88, v240, v241
    v_cvt_pk_bf16_f32 v89, v242, v243
    v_cvt_pk_bf16_f32 v90, v244, v245
    v_cvt_pk_bf16_f32 v91, v246, v247
    v_pk_max_i16 v88, v88, 0
    v_pk_max_i16 v89, v89, 0
    v_pk_max_i16 v90, v90, 0
    v_pk_max_i16 v91, v91, 0
    buffer_store_dwordx4 v[88:91], v2, s[56:59], s77 offen offset:2048 sc1
    v_cvt_pk_bf16_f32 v92, v248, v249
    v_cvt_pk_bf16_f32 v93, v250, v251
    v_cvt_pk_bf16_f32 v94, v252, v253
    v_cvt_pk_bf16_f32 v95, v254, v255
    v_pk_max_i16 v92, v92, 0
    v_pk_max_i16 v93, v93, 0
    v_pk_max_i16 v94, v94, 0
    v_pk_max_i16 v95, v95, 0
    buffer_store_dwordx4 v[92:95], v2, s[56:59], s77 offen offset:2560 sc1
    s_mul_i32 s41, s38, 22
    s_mul_i32 s42, s22, 88
    s_add_u32 s42, s42, s41
    s_lshl_b32 s42, s42, 12
    s_add_u32 s60, s34, s42
    s_addc_u32 s61, s35, 0
    s_mov_b32 s62, 90112
    s_mov_b32 s63, 0x20000
    s_waitcnt vmcnt(0)
    s_barrier
    s_cmp_lg_u32 s38, 0
    s_cbranch_scc1 L_sig_ffn
    v_readfirstlane_b32 s47, v46
    s_nop 3
    s_cmp_lg_u32 s47, 0
    s_cbranch_scc1 L_nc_ffn
    v_mov_b32 v47, 0
    global_load_dword v46, v47, s[32:33] sc0 sc1
    s_mov_b32 s43, 0
L_nw_ffn:
    s_waitcnt vmcnt(0)
    v_readfirstlane_b32 s47, v46
    s_nop 3
    s_cmp_lg_u32 s47, 0
    s_cbranch_scc1 L_nw_done_ffn
    s_add_u32 s43, s43, 1
    s_cmp_lt_u32 s43, 0x100000
    s_cbranch_scc0 L_nw_done_ffn
    v_mov_b32 v47, 0
    global_load_dword v46, v47, s[32:33] sc0 sc1
    s_branch L_nw_ffn
L_nw_done_ffn:
L_nc_ffn:
    v_mov_b32 v124, s98
    v_mov_b32 v125, s47
    s_mov_b64 exec, 1
    buffer_store_dword v125, v124, s[56:59], 0 offen sc0 sc1
    s_mov_b64 exec, -1
    buffer_load_dword v50, v51, s[56:59], 0 offen sc0 sc1
    s_mov_b32 s43, 0
L_wc_ffn:
    s_waitcnt vmcnt(0)
    v_cmp_ne_u32 vcc, s47, v50
    s_nop 1
    s_cmp_eq_u64 vcc, 0
    s_cbranch_scc1 L_wc_done_ffn
    s_add_u32 s43, s43, 1
    s_cmp_lt_u32 s43, 0x100000
    s_cbranch_scc0 L_wc_done_ffn
    buffer_load_dword v50, v51, s[56:59], 0 offen sc0 sc1
    s_branch L_wc_ffn
L_wc_done_ffn:
L_sig_ffn:
    s_barrier
    s_mov_b32 s71, 0
    buffer_load_dwordx4 a[0:3], v48, s[52:55], s71 offen offset:0 sc1
    buffer_load_dwordx4 a[4:7], v48, s[52:55], s71 offen offset:1024 sc1
    buffer_load_dwordx4 a[8:11], v48, s[52:55], s71 offen offset:2048 sc1
    buffer_load_dwordx4 a[12:15], v48, s[52:55], s71 offen offset:3072 sc1
    buffer_load_dwordx4 a[16:19], v49, s[52:55], s71 offen sc1
    s_mov_b32 s71, 5120
    buffer_load_dwordx4 a[20:23], v48, s[52:55], s71 offen offset:0 sc1
    buffer_load_dwordx4 a[24:27], v48, s[52:55], s71 offen offset:1024 sc1
    buffer_load_dwordx4 a[28:31], v48, s[52:55], s71 offen offset:2048 sc1
    buffer_load_dwordx4 a[32:35], v48, s[52:55], s71 offen offset:3072 sc1
    buffer_load_dwordx4 a[36:39], v49, s[52:55], s71 offen sc1
    s_mov_b32 s71, 10240
    buffer_load_dwordx4 a[40:43], v48, s[52:55], s71 offen offset:0 sc1
    buffer_load_dwordx4 a[44:47], v48, s[52:55], s71 offen offset:1024 sc1
    buffer_load_dwordx4 a[48:51], v48, s[52:55], s71 offen offset:2048 sc1
    buffer_load_dwordx4 a[52:55], v48, s[52:55], s71 offen offset:3072 sc1
    buffer_load_dwordx4 a[56:59], v49, s[52:55], s71 offen sc1
    s_mov_b32 s71, 15360
    buffer_load_dwordx4 a[60:63], v48, s[52:55], s71 offen offset:0 sc1
    buffer_load_dwordx4 a[64:67], v48, s[52:55], s71 offen offset:1024 sc1
    buffer_load_dwordx4 a[68:71], v48, s[52:55], s71 offen offset:2048 sc1
    buffer_load_dwordx4 a[72:75], v48, s[52:55], s71 offen offset:3072 sc1
    buffer_load_dwordx4 a[76:79], v49, s[52:55], s71 offen sc1
    s_mov_b32 s71, 20480
    buffer_load_dwordx4 a[80:83], v48, s[52:55], s71 offen offset:0 sc1
    buffer_load_dwordx4 a[84:87], v48, s[52:55], s71 offen offset:1024 sc1
    buffer_load_dwordx4 a[88:91], v48, s[52:55], s71 offen offset:2048 sc1
    buffer_load_dwordx4 a[92:95], v48, s[52:55], s71 offen offset:3072 sc1
    buffer_load_dwordx4 a[96:99], v49, s[52:55], s71 offen sc1
    s_mov_b32 s71, 25600
    buffer_load_dwordx4 a[100:103], v48, s[52:55], s71 offen offset:0 sc1
    buffer_load_dwordx4 a[104:107], v48, s[52:55], s71 offen offset:1024 sc1
    buffer_load_dwordx4 a[108:111], v48, s[52:55], s71 offen offset:2048 sc1
    buffer_load_dwordx4 a[112:115], v48, s[52:55], s71 offen offset:3072 sc1
    buffer_load_dwordx4 a[116:119], v49, s[52:55], s71 offen sc1
    s_mov_b32 s71, 30720
    buffer_load_dwordx4 a[120:123], v48, s[52:55], s71 offen offset:0 sc1
    buffer_load_dwordx4 a[124:127], v48, s[52:55], s71 offen offset:1024 sc1
    buffer_load_dwordx4 a[128:131], v48, s[52:55], s71 offen offset:2048 sc1
    buffer_load_dwordx4 a[132:135], v48, s[52:55], s71 offen offset:3072 sc1
    buffer_load_dwordx4 a[136:139], v49, s[52:55], s71 offen sc1
    s_mov_b32 s71, 35840
    buffer_load_dwordx4 a[140:143], v48, s[52:55], s71 offen offset:0 sc1
    buffer_load_dwordx4 a[144:147], v48, s[52:55], s71 offen offset:1024 sc1
    buffer_load_dwordx4 a[148:151], v48, s[52:55], s71 offen offset:2048 sc1
    buffer_load_dwordx4 a[152:155], v48, s[52:55], s71 offen offset:3072 sc1
    buffer_load_dwordx4 a[156:159], v49, s[52:55], s71 offen sc1
    s_mov_b32 s71, 40960
    buffer_load_dwordx4 a[160:163], v48, s[52:55], s71 offen offset:0 sc1
    buffer_load_dwordx4 a[164:167], v48, s[52:55], s71 offen offset:1024 sc1
    buffer_load_dwordx4 a[168:171], v48, s[52:55], s71 offen offset:2048 sc1
    buffer_load_dwordx4 a[172:175], v48, s[52:55], s71 offen offset:3072 sc1
    buffer_load_dwordx4 a[176:179], v49, s[52:55], s71 offen sc1
    s_cmp_lg_u32 s38, 0
    s_cbranch_scc1 L_ep_ffn
    s_lshr_b32 s41, s22, 1
    s_lshl_b32 s41, s41, 4
    v_add_u32 v5, s41, v1
    v_lshlrev_b32 v5, 7, v5
    v_add_u32 v5, 15310848, v5
    s_mov_b32 exec_lo, 0xffff
    s_mov_b32 exec_hi, 0
    buffer_load_dword v4, v5, s[56:59], 0 offen sc0 sc1
    s_mov_b64 exec, -1
L_ep_ffn:
    s_mov_b32 s71, 46080
    buffer_load_dwordx4 a[180:183], v48, s[52:55], s71 offen offset:0 sc1
    buffer_load_dwordx4 a[184:187], v48, s[52:55], s71 offen offset:1024 sc1
    buffer_load_dwordx4 a[188:191], v48, s[52:55], s71 offen offset:2048 sc1
    buffer_load_dwordx4 a[192:195], v48, s[52:55], s71 offen offset:3072 sc1
    buffer_load_dwordx4 a[196:199], v49, s[52:55], s71 offen sc1
    s_mov_b32 s71, 51200
    buffer_load_dwordx4 a[200:203], v48, s[52:55], s71 offen offset:0 sc1
    buffer_load_dwordx4 a[204:207], v48, s[52:55], s71 offen offset:1024 sc1
    buffer_load_dwordx4 a[208:211], v48, s[52:55], s71 offen offset:2048 sc1
    buffer_load_dwordx4 a[212:215], v48, s[52:55], s71 offen offset:3072 sc1
    buffer_load_dwordx4 a[216:219], v49, s[52:55], s71 offen sc1
    s_mov_b32 s71, 56320
    buffer_load_dwordx4 a[220:223], v48, s[52:55], s71 offen offset:0 sc1
    buffer_load_dwordx4 a[224:227], v48, s[52:55], s71 offen offset:1024 sc1
    buffer_load_dwordx4 a[228:231], v48, s[52:55], s71 offen offset:2048 sc1
    buffer_load_dwordx4 a[232:235], v48, s[52:55], s71 offen offset:3072 sc1
    buffer_load_dwordx4 a[236:239], v49, s[52:55], s71 offen sc1
L_phase2:
    v_lshlrev_b32 v2, 4, v1
    v_add_u32 v3, 4096, v2
    s_cmp_lg_u32 s38, 0
    s_cbranch_scc1 L_p2_go
    s_mov_b32 exec_lo, 0xffff
    s_mov_b32 exec_hi, 0
    s_mov_b32 s43, 0
    s_waitcnt vmcnt(15)
    s_branch L_p2_check
L_p2_poll:
    buffer_load_dword v4, v5, s[56:59], 0 offen sc0 sc1
    s_waitcnt vmcnt(0)
L_p2_check:
    v_cmp_ne_u32 vcc, s47, v4
    s_nop 1
    s_cmp_eq_u64 vcc, 0
    s_cbranch_scc1 L_p2_poll_done
    s_add_u32 s43, s43, 1
    s_cmp_lt_u32 s43, 0x100000
    s_cbranch_scc0 L_p2_poll_done
    s_branch L_p2_poll
L_p2_poll_done:
    s_mov_b64 exec, -1
L_p2_go:
    s_barrier
    s_mov_b32 s68, 0
    buffer_load_dwordx4 v[74:77], v2, s[60:63], s68 offen offset:0 sc1
    buffer_load_dwordx4 v[78:81], v2, s[60:63], s68 offen offset:1024 sc1
    buffer_load_dwordx4 v[82:85], v2, s[60:63], s68 offen offset:2048 sc1
    s_waitcnt vmcnt(60)
    buffer_load_dwordx4 v[86:89], v2, s[60:63], s68 offen offset:3072 sc1
    s_mov_b32 s68, 4096
    buffer_load_dwordx4 v[90:93], v2, s[60:63], s68 offen offset:0 sc1
    buffer_load_dwordx4 v[94:97], v2, s[60:63], s68 offen offset:1024 sc1
    s_waitcnt vmcnt(60)
    buffer_load_dwordx4 v[98:101], v2, s[60:63], s68 offen offset:2048 sc1
    buffer_load_dwordx4 v[102:105], v2, s[60:63], s68 offen offset:3072 sc1
    s_mov_b32 s68, 8192
    buffer_load_dwordx4 v[106:109], v2, s[60:63], s68 offen offset:0 sc1
    s_waitcnt vmcnt(60)
    buffer_load_dwordx4 v[110:113], v2, s[60:63], s68 offen offset:1024 sc1
    buffer_load_dwordx4 v[114:117], v2, s[60:63], s68 offen offset:2048 sc1
    buffer_load_dwordx4 v[118:121], v2, s[60:63], s68 offen offset:3072 sc1
    s_mov_b32 s68, 12288
    s_waitcnt vmcnt(60)
    buffer_load_dwordx4 v[122:125], v2, s[60:63], s68 offen offset:0 sc1
    buffer_load_dwordx4 v[126:129], v2, s[60:63], s68 offen offset:1024 sc1
    buffer_load_dwordx4 v[130:133], v2, s[60:63], s68 offen offset:2048 sc1
    s_waitcnt vmcnt(60)
    buffer_load_dwordx4 v[134:137], v2, s[60:63], s68 offen offset:3072 sc1
    s_mov_b32 s68, 16384
    buffer_load_dwordx4 v[138:141], v2, s[60:63], s68 offen offset:0 sc1
    buffer_load_dwordx4 v[142:145], v2, s[60:63], s68 offen offset:1024 sc1
    s_waitcnt vmcnt(60)
    buffer_load_dwordx4 v[146:149], v2, s[60:63], s68 offen offset:2048 sc1
    buffer_load_dwordx4 v[150:153], v2, s[60:63], s68 offen offset:3072 sc1
    s_mov_b32 s68, 20480
    buffer_load_dwordx4 v[154:157], v2, s[60:63], s68 offen offset:0 sc1
    s_waitcnt vmcnt(60)
    buffer_load_dwordx4 v[158:161], v2, s[60:63], s68 offen offset:1024 sc1
    buffer_load_dwordx4 v[162:165], v2, s[60:63], s68 offen offset:2048 sc1
    buffer_load_dwordx4 v[166:169], v2, s[60:63], s68 offen offset:3072 sc1
    s_waitcnt vmcnt(20)
    v_mfma_f32_16x16x32_bf16 v[176:179], a[0:3], v[74:77], 0
    v_mfma_f32_16x16x32_bf16 v[180:183], a[4:7], v[74:77], 0
    v_mfma_f32_16x16x32_bf16 v[184:187], a[8:11], v[74:77], 0
    v_mfma_f32_16x16x32_bf16 v[188:191], a[12:15], v[74:77], 0
    v_mfma_f32_16x16x32_bf16 v[192:195], a[16:19], v[74:77], 0
    s_mov_b32 s68, 24576
    buffer_load_dwordx4 v[74:77], v2, s[60:63], s68 offen offset:0 sc1
    v_mfma_f32_16x16x32_bf16 v[196:199], a[0:3], v[78:81], 0
    v_mfma_f32_16x16x32_bf16 v[200:203], a[4:7], v[78:81], 0
    v_mfma_f32_16x16x32_bf16 v[204:207], a[8:11], v[78:81], 0
    v_mfma_f32_16x16x32_bf16 v[208:211], a[12:15], v[78:81], 0
    v_mfma_f32_16x16x32_bf16 v[212:215], a[16:19], v[78:81], 0
    buffer_load_dwordx4 v[78:81], v2, s[60:63], s68 offen offset:1024 sc1
    v_mfma_f32_16x16x32_bf16 v[216:219], a[0:3], v[82:85], 0
    v_mfma_f32_16x16x32_bf16 v[220:223], a[4:7], v[82:85], 0
    v_mfma_f32_16x16x32_bf16 v[224:227], a[8:11], v[82:85], 0
    v_mfma_f32_16x16x32_bf16 v[228:231], a[12:15], v[82:85], 0
    v_mfma_f32_16x16x32_bf16 v[232:235], a[16:19], v[82:85], 0
    buffer_load_dwordx4 v[82:85], v2, s[60:63], s68 offen offset:2048 sc1
    v_mfma_f32_16x16x32_bf16 v[236:239], a[0:3], v[86:89], 0
    v_mfma_f32_16x16x32_bf16 v[240:243], a[4:7], v[86:89], 0
    v_mfma_f32_16x16x32_bf16 v[244:247], a[8:11], v[86:89], 0
    v_mfma_f32_16x16x32_bf16 v[248:251], a[12:15], v[86:89], 0
    v_mfma_f32_16x16x32_bf16 v[252:255], a[16:19], v[86:89], 0
    buffer_load_dwordx4 v[86:89], v2, s[60:63], s68 offen offset:3072 sc1
    s_waitcnt vmcnt(20)
    v_mfma_f32_16x16x32_bf16 v[176:179], a[20:23], v[90:93], v[176:179]
    v_mfma_f32_16x16x32_bf16 v[180:183], a[24:27], v[90:93], v[180:183]
    s_mov_b32 s71, 61440
    buffer_load_dwordx4 a[240:243], v2, s[52:55], s71 offen offset:0 sc1
    v_mfma_f32_16x16x32_bf16 v[184:187], a[28:31], v[90:93], v[184:187]
    v_mfma_f32_16x16x32_bf16 v[188:191], a[32:35], v[90:93], v[188:191]
    v_mfma_f32_16x16x32_bf16 v[192:195], a[36:39], v[90:93], v[192:195]
    s_mov_b32 s68, 28672
    buffer_load_dwordx4 v[90:93], v2, s[60:63], s68 offen offset:0 sc1
    v_mfma_f32_16x16x32_bf16 v[196:199], a[20:23], v[94:97], v[196:199]
    buffer_load_dwordx4 a[244:247], v2, s[52:55], s71 offen offset:1024 sc1
    v_mfma_f32_16x16x32_bf16 v[200:203], a[24:27], v[94:97], v[200:203]
    v_mfma_f32_16x16x32_bf16 v[204:207], a[28:31], v[94:97], v[204:207]
    v_mfma_f32_16x16x32_bf16 v[208:211], a[32:35], v[94:97], v[208:211]
    v_mfma_f32_16x16x32_bf16 v[212:215], a[36:39], v[94:97], v[212:215]
    buffer_load_dwordx4 a[248:251], v2, s[52:55], s71 offen offset:2048 sc1
    buffer_load_dwordx4 v[94:97], v2, s[60:63], s68 offen offset:1024 sc1
    v_mfma_f32_16x16x32_bf16 v[216:219], a[20:23], v[98:101], v[216:219]
    v_mfma_f32_16x16x32_bf16 v[220:223], a[24:27], v[98:101], v[220:223]
    v_mfma_f32_16x16x32_bf16 v[224:227], a[28:31], v[98:101], v[224:227]
    v_mfma_f32_16x16x32_bf16 v[228:231], a[32:35], v[98:101], v[228:231]
    v_mfma_f32_16x16x32_bf16 v[232:235], a[36:39], v[98:101], v[232:235]
    buffer_load_dwordx4 v[98:101], v2, s[60:63], s68 offen offset:2048 sc1
    v_mfma_f32_16x16x32_bf16 v[236:239], a[20:23], v[102:105], v[236:239]
    v_mfma_f32_16x16x32_bf16 v[240:243], a[24:27], v[102:105], v[240:243]
    v_mfma_f32_16x16x32_bf16 v[244:247], a[28:31], v[102:105], v[244:247]
    v_mfma_f32_16x16x32_bf16 v[248:251], a[32:35], v[102:105], v[248:251]
    v_mfma_f32_16x16x32_bf16 v[252:255], a[36:39], v[102:105], v[252:255]
    buffer_load_dwordx4 v[102:105], v2, s[60:63], s68 offen offset:3072 sc1
    s_waitcnt vmcnt(23)
    v_mfma_f32_16x16x32_bf16 v[176:179], a[40:43], v[106:109], v[176:179]
    v_mfma_f32_16x16x32_bf16 v[180:183], a[44:47], v[106:109], v[180:183]
    buffer_load_dwordx4 a[252:255], v2, s[52:55], s71 offen offset:3072 sc1
    v_mfma_f32_16x16x32_bf16 v[184:187], a[48:51], v[106:109], v[184:187]
    v_mfma_f32_16x16x32_bf16 v[188:191], a[52:55], v[106:109], v[188:191]
    v_mfma_f32_16x16x32_bf16 v[192:195], a[56:59], v[106:109], v[192:195]
    s_mov_b32 s68, 32768
    buffer_load_dwordx4 v[106:109], v2, s[60:63], s68 offen offset:0 sc1
    v_mfma_f32_16x16x32_bf16 v[196:199], a[40:43], v[110:113], v[196:199]
    buffer_load_dwordx4 v[50:53], v3, s[52:55], s71 offen sc1
    v_mfma_f32_16x16x32_bf16 v[200:203], a[44:47], v[110:113], v[200:203]
    v_mfma_f32_16x16x32_bf16 v[204:207], a[48:51], v[110:113], v[204:207]
    v_mfma_f32_16x16x32_bf16 v[208:211], a[52:55], v[110:113], v[208:211]
    v_mfma_f32_16x16x32_bf16 v[212:215], a[56:59], v[110:113], v[212:215]
    s_mov_b32 s71, 66560
    buffer_load_dwordx4 v[54:57], v2, s[52:55], s71 offen offset:0 sc1
    buffer_load_dwordx4 v[110:113], v2, s[60:63], s68 offen offset:1024 sc1
    v_mfma_f32_16x16x32_bf16 v[216:219], a[40:43], v[114:117], v[216:219]
    v_mfma_f32_16x16x32_bf16 v[220:223], a[44:47], v[114:117], v[220:223]
    v_mfma_f32_16x16x32_bf16 v[224:227], a[48:51], v[114:117], v[224:227]
    v_mfma_f32_16x16x32_bf16 v[228:231], a[52:55], v[114:117], v[228:231]
    v_mfma_f32_16x16x32_bf16 v[232:235], a[56:59], v[114:117], v[232:235]
    buffer_load_dwordx4 v[114:117], v2, s[60:63], s68 offen offset:2048 sc1
    v_mfma_f32_16x16x32_bf16 v[236:239], a[40:43], v[118:121], v[236:239]
    v_mfma_f32_16x16x32_bf16 v[240:243], a[44:47], v[118:121], v[240:243]
    v_mfma_f32_16x16x32_bf16 v[244:247], a[48:51], v[118:121], v[244:247]
    v_mfma_f32_16x16x32_bf16 v[248:251], a[52:55], v[118:121], v[248:251]
    v_mfma_f32_16x16x32_bf16 v[252:255], a[56:59], v[118:121], v[252:255]
    buffer_load_dwordx4 v[118:121], v2, s[60:63], s68 offen offset:3072 sc1
    s_waitcnt vmcnt(26)
    v_mfma_f32_16x16x32_bf16 v[176:179], a[60:63], v[122:125], v[176:179]
    v_mfma_f32_16x16x32_bf16 v[180:183], a[64:67], v[122:125], v[180:183]
    buffer_load_dwordx4 v[58:61], v2, s[52:55], s71 offen offset:1024 sc1
    v_mfma_f32_16x16x32_bf16 v[184:187], a[68:71], v[122:125], v[184:187]
    v_mfma_f32_16x16x32_bf16 v[188:191], a[72:75], v[122:125], v[188:191]
    v_mfma_f32_16x16x32_bf16 v[192:195], a[76:79], v[122:125], v[192:195]
    s_mov_b32 s68, 36864
    buffer_load_dwordx4 v[122:125], v2, s[60:63], s68 offen offset:0 sc1
    v_mfma_f32_16x16x32_bf16 v[196:199], a[60:63], v[126:129], v[196:199]
    buffer_load_dwordx4 v[62:65], v2, s[52:55], s71 offen offset:2048 sc1
    v_mfma_f32_16x16x32_bf16 v[200:203], a[64:67], v[126:129], v[200:203]
    v_mfma_f32_16x16x32_bf16 v[204:207], a[68:71], v[126:129], v[204:207]
    v_mfma_f32_16x16x32_bf16 v[208:211], a[72:75], v[126:129], v[208:211]
    v_mfma_f32_16x16x32_bf16 v[212:215], a[76:79], v[126:129], v[212:215]
    buffer_load_dwordx4 v[66:69], v2, s[52:55], s71 offen offset:3072 sc1
    buffer_load_dwordx4 v[126:129], v2, s[60:63], s68 offen offset:1024 sc1
    v_mfma_f32_16x16x32_bf16 v[216:219], a[60:63], v[130:133], v[216:219]
    v_mfma_f32_16x16x32_bf16 v[220:223], a[64:67], v[130:133], v[220:223]
    v_mfma_f32_16x16x32_bf16 v[224:227], a[68:71], v[130:133], v[224:227]
    v_mfma_f32_16x16x32_bf16 v[228:231], a[72:75], v[130:133], v[228:231]
    v_mfma_f32_16x16x32_bf16 v[232:235], a[76:79], v[130:133], v[232:235]
    buffer_load_dwordx4 v[130:133], v2, s[60:63], s68 offen offset:2048 sc1
    v_mfma_f32_16x16x32_bf16 v[236:239], a[60:63], v[134:137], v[236:239]
    v_mfma_f32_16x16x32_bf16 v[240:243], a[64:67], v[134:137], v[240:243]
    v_mfma_f32_16x16x32_bf16 v[244:247], a[68:71], v[134:137], v[244:247]
    v_mfma_f32_16x16x32_bf16 v[248:251], a[72:75], v[134:137], v[248:251]
    v_mfma_f32_16x16x32_bf16 v[252:255], a[76:79], v[134:137], v[252:255]
    buffer_load_dwordx4 v[134:137], v2, s[60:63], s68 offen offset:3072 sc1
    s_waitcnt vmcnt(29)
    v_mfma_f32_16x16x32_bf16 v[176:179], a[80:83], v[138:141], v[176:179]
    v_mfma_f32_16x16x32_bf16 v[180:183], a[84:87], v[138:141], v[180:183]
    buffer_load_dwordx4 v[70:73], v3, s[52:55], s71 offen sc1
    v_mfma_f32_16x16x32_bf16 v[184:187], a[88:91], v[138:141], v[184:187]
    v_mfma_f32_16x16x32_bf16 v[188:191], a[92:95], v[138:141], v[188:191]
    v_mfma_f32_16x16x32_bf16 v[192:195], a[96:99], v[138:141], v[192:195]
    s_mov_b32 s68, 40960
    buffer_load_dwordx4 v[138:141], v2, s[60:63], s68 offen offset:0 sc1
    v_mfma_f32_16x16x32_bf16 v[196:199], a[80:83], v[142:145], v[196:199]
    s_mov_b32 s71, 71680
    buffer_load_dwordx4 a[0:3], v2, s[52:55], s71 offen offset:0 sc1
    v_mfma_f32_16x16x32_bf16 v[200:203], a[84:87], v[142:145], v[200:203]
    v_mfma_f32_16x16x32_bf16 v[204:207], a[88:91], v[142:145], v[204:207]
    v_mfma_f32_16x16x32_bf16 v[208:211], a[92:95], v[142:145], v[208:211]
    v_mfma_f32_16x16x32_bf16 v[212:215], a[96:99], v[142:145], v[212:215]
    buffer_load_dwordx4 a[4:7], v2, s[52:55], s71 offen offset:1024 sc1
    buffer_load_dwordx4 v[142:145], v2, s[60:63], s68 offen offset:1024 sc1
    v_mfma_f32_16x16x32_bf16 v[216:219], a[80:83], v[146:149], v[216:219]
    v_mfma_f32_16x16x32_bf16 v[220:223], a[84:87], v[146:149], v[220:223]
    v_mfma_f32_16x16x32_bf16 v[224:227], a[88:91], v[146:149], v[224:227]
    v_mfma_f32_16x16x32_bf16 v[228:231], a[92:95], v[146:149], v[228:231]
    v_mfma_f32_16x16x32_bf16 v[232:235], a[96:99], v[146:149], v[232:235]
    buffer_load_dwordx4 v[146:149], v2, s[60:63], s68 offen offset:2048 sc1
    v_mfma_f32_16x16x32_bf16 v[236:239], a[80:83], v[150:153], v[236:239]
    v_mfma_f32_16x16x32_bf16 v[240:243], a[84:87], v[150:153], v[240:243]
    v_mfma_f32_16x16x32_bf16 v[244:247], a[88:91], v[150:153], v[244:247]
    v_mfma_f32_16x16x32_bf16 v[248:251], a[92:95], v[150:153], v[248:251]
    v_mfma_f32_16x16x32_bf16 v[252:255], a[96:99], v[150:153], v[252:255]
    buffer_load_dwordx4 v[150:153], v2, s[60:63], s68 offen offset:3072 sc1
    s_waitcnt vmcnt(32)
    v_mfma_f32_16x16x32_bf16 v[176:179], a[100:103], v[154:157], v[176:179]
    v_mfma_f32_16x16x32_bf16 v[180:183], a[104:107], v[154:157], v[180:183]
    buffer_load_dwordx4 a[8:11], v2, s[52:55], s71 offen offset:2048 sc1
    v_mfma_f32_16x16x32_bf16 v[184:187], a[108:111], v[154:157], v[184:187]
    v_mfma_f32_16x16x32_bf16 v[188:191], a[112:115], v[154:157], v[188:191]
    v_mfma_f32_16x16x32_bf16 v[192:195], a[116:119], v[154:157], v[192:195]
    s_mov_b32 s68, 45056
    buffer_load_dwordx4 v[154:157], v2, s[60:63], s68 offen offset:0 sc1
    v_mfma_f32_16x16x32_bf16 v[196:199], a[100:103], v[158:161], v[196:199]
    buffer_load_dwordx4 a[12:15], v2, s[52:55], s71 offen offset:3072 sc1
    v_mfma_f32_16x16x32_bf16 v[200:203], a[104:107], v[158:161], v[200:203]
    v_mfma_f32_16x16x32_bf16 v[204:207], a[108:111], v[158:161], v[204:207]
    v_mfma_f32_16x16x32_bf16 v[208:211], a[112:115], v[158:161], v[208:211]
    v_mfma_f32_16x16x32_bf16 v[212:215], a[116:119], v[158:161], v[212:215]
    buffer_load_dwordx4 a[16:19], v3, s[52:55], s71 offen sc1
    buffer_load_dwordx4 v[158:161], v2, s[60:63], s68 offen offset:1024 sc1
    v_mfma_f32_16x16x32_bf16 v[216:219], a[100:103], v[162:165], v[216:219]
    v_mfma_f32_16x16x32_bf16 v[220:223], a[104:107], v[162:165], v[220:223]
    v_mfma_f32_16x16x32_bf16 v[224:227], a[108:111], v[162:165], v[224:227]
    v_mfma_f32_16x16x32_bf16 v[228:231], a[112:115], v[162:165], v[228:231]
    v_mfma_f32_16x16x32_bf16 v[232:235], a[116:119], v[162:165], v[232:235]
    buffer_load_dwordx4 v[162:165], v2, s[60:63], s68 offen offset:2048 sc1
    v_mfma_f32_16x16x32_bf16 v[236:239], a[100:103], v[166:169], v[236:239]
    v_mfma_f32_16x16x32_bf16 v[240:243], a[104:107], v[166:169], v[240:243]
    v_mfma_f32_16x16x32_bf16 v[244:247], a[108:111], v[166:169], v[244:247]
    v_mfma_f32_16x16x32_bf16 v[248:251], a[112:115], v[166:169], v[248:251]
    v_mfma_f32_16x16x32_bf16 v[252:255], a[116:119], v[166:169], v[252:255]
    buffer_load_dwordx4 v[166:169], v2, s[60:63], s68 offen offset:3072 sc1
    s_waitcnt vmcnt(35)
    v_mfma_f32_16x16x32_bf16 v[176:179], a[120:123], v[74:77], v[176:179]
    v_mfma_f32_16x16x32_bf16 v[180:183], a[124:127], v[74:77], v[180:183]
    s_mov_b32 s71, 76800
    buffer_load_dwordx4 a[20:23], v2, s[52:55], s71 offen offset:0 sc1
    v_mfma_f32_16x16x32_bf16 v[184:187], a[128:131], v[74:77], v[184:187]
    v_mfma_f32_16x16x32_bf16 v[188:191], a[132:135], v[74:77], v[188:191]
    v_mfma_f32_16x16x32_bf16 v[192:195], a[136:139], v[74:77], v[192:195]
    s_mov_b32 s68, 49152
    buffer_load_dwordx4 v[74:77], v2, s[60:63], s68 offen offset:0 sc1
    v_mfma_f32_16x16x32_bf16 v[196:199], a[120:123], v[78:81], v[196:199]
    buffer_load_dwordx4 a[24:27], v2, s[52:55], s71 offen offset:1024 sc1
    v_mfma_f32_16x16x32_bf16 v[200:203], a[124:127], v[78:81], v[200:203]
    v_mfma_f32_16x16x32_bf16 v[204:207], a[128:131], v[78:81], v[204:207]
    v_mfma_f32_16x16x32_bf16 v[208:211], a[132:135], v[78:81], v[208:211]
    v_mfma_f32_16x16x32_bf16 v[212:215], a[136:139], v[78:81], v[212:215]
    buffer_load_dwordx4 a[28:31], v2, s[52:55], s71 offen offset:2048 sc1
    buffer_load_dwordx4 v[78:81], v2, s[60:63], s68 offen offset:1024 sc1
    v_mfma_f32_16x16x32_bf16 v[216:219], a[120:123], v[82:85], v[216:219]
    v_mfma_f32_16x16x32_bf16 v[220:223], a[124:127], v[82:85], v[220:223]
    v_mfma_f32_16x16x32_bf16 v[224:227], a[128:131], v[82:85], v[224:227]
    v_mfma_f32_16x16x32_bf16 v[228:231], a[132:135], v[82:85], v[228:231]
    v_mfma_f32_16x16x32_bf16 v[232:235], a[136:139], v[82:85], v[232:235]
    buffer_load_dwordx4 v[82:85], v2, s[60:63], s68 offen offset:2048 sc1
    v_mfma_f32_16x16x32_bf16 v[236:239], a[120:123], v[86:89], v[236:239]
    v_mfma_f32_16x16x32_bf16 v[240:243], a[124:127], v[86:89], v[240:243]
    v_mfma_f32_16x16x32_bf16 v[244:247], a[128:131], v[86:89], v[244:247]
    v_mfma_f32_16x16x32_bf16 v[248:251], a[132:135], v[86:89], v[248:251]
    v_mfma_f32_16x16x32_bf16 v[252:255], a[136:139], v[86:89], v[252:255]
    buffer_load_dwordx4 v[86:89], v2, s[60:63], s68 offen offset:3072 sc1
    s_waitcnt vmcnt(35)
    v_mfma_f32_16x16x32_bf16 v[176:179], a[140:143], v[90:93], v[176:179]
    v_mfma_f32_16x16x32_bf16 v[180:183], a[144:147], v[90:93], v[180:183]
    buffer_load_dwordx4 a[32:35], v2, s[52:55], s71 offen offset:3072 sc1
    v_mfma_f32_16x16x32_bf16 v[184:187], a[148:151], v[90:93], v[184:187]
    v_mfma_f32_16x16x32_bf16 v[188:191], a[152:155], v[90:93], v[188:191]
    v_mfma_f32_16x16x32_bf16 v[192:195], a[156:159], v[90:93], v[192:195]
    s_mov_b32 s68, 53248
    buffer_load_dwordx4 v[90:93], v2, s[60:63], s68 offen offset:0 sc1
    v_mfma_f32_16x16x32_bf16 v[196:199], a[140:143], v[94:97], v[196:199]
    buffer_load_dwordx4 a[36:39], v3, s[52:55], s71 offen sc1
    v_mfma_f32_16x16x32_bf16 v[200:203], a[144:147], v[94:97], v[200:203]
    v_mfma_f32_16x16x32_bf16 v[204:207], a[148:151], v[94:97], v[204:207]
    v_mfma_f32_16x16x32_bf16 v[208:211], a[152:155], v[94:97], v[208:211]
    v_mfma_f32_16x16x32_bf16 v[212:215], a[156:159], v[94:97], v[212:215]
    s_mov_b32 s71, 81920
    buffer_load_dwordx4 a[40:43], v2, s[52:55], s71 offen offset:0 sc1
    buffer_load_dwordx4 v[94:97], v2, s[60:63], s68 offen offset:1024 sc1
    v_mfma_f32_16x16x32_bf16 v[216:219], a[140:143], v[98:101], v[216:219]
    v_mfma_f32_16x16x32_bf16 v[220:223], a[144:147], v[98:101], v[220:223]
    v_mfma_f32_16x16x32_bf16 v[224:227], a[148:151], v[98:101], v[224:227]
    v_mfma_f32_16x16x32_bf16 v[228:231], a[152:155], v[98:101], v[228:231]
    v_mfma_f32_16x16x32_bf16 v[232:235], a[156:159], v[98:101], v[232:235]
    buffer_load_dwordx4 v[98:101], v2, s[60:63], s68 offen offset:2048 sc1
    v_mfma_f32_16x16x32_bf16 v[236:239], a[140:143], v[102:105], v[236:239]
    v_mfma_f32_16x16x32_bf16 v[240:243], a[144:147], v[102:105], v[240:243]
    v_mfma_f32_16x16x32_bf16 v[244:247], a[148:151], v[102:105], v[244:247]
    v_mfma_f32_16x16x32_bf16 v[248:251], a[152:155], v[102:105], v[248:251]
    v_mfma_f32_16x16x32_bf16 v[252:255], a[156:159], v[102:105], v[252:255]
    buffer_load_dwordx4 v[102:105], v2, s[60:63], s68 offen offset:3072 sc1
    s_waitcnt vmcnt(35)
    v_mfma_f32_16x16x32_bf16 v[176:179], a[160:163], v[106:109], v[176:179]
    v_mfma_f32_16x16x32_bf16 v[180:183], a[164:167], v[106:109], v[180:183]
    buffer_load_dwordx4 a[44:47], v2, s[52:55], s71 offen offset:1024 sc1
    v_mfma_f32_16x16x32_bf16 v[184:187], a[168:171], v[106:109], v[184:187]
    v_mfma_f32_16x16x32_bf16 v[188:191], a[172:175], v[106:109], v[188:191]
    v_mfma_f32_16x16x32_bf16 v[192:195], a[176:179], v[106:109], v[192:195]
    s_mov_b32 s68, 57344
    buffer_load_dwordx4 v[106:109], v2, s[60:63], s68 offen offset:0 sc1
    v_mfma_f32_16x16x32_bf16 v[196:199], a[160:163], v[110:113], v[196:199]
    buffer_load_dwordx4 a[48:51], v2, s[52:55], s71 offen offset:2048 sc1
    v_mfma_f32_16x16x32_bf16 v[200:203], a[164:167], v[110:113], v[200:203]
    v_mfma_f32_16x16x32_bf16 v[204:207], a[168:171], v[110:113], v[204:207]
    v_mfma_f32_16x16x32_bf16 v[208:211], a[172:175], v[110:113], v[208:211]
    v_mfma_f32_16x16x32_bf16 v[212:215], a[176:179], v[110:113], v[212:215]
    buffer_load_dwordx4 a[52:55], v2, s[52:55], s71 offen offset:3072 sc1
    buffer_load_dwordx4 v[110:113], v2, s[60:63], s68 offen offset:1024 sc1
    v_mfma_f32_16x16x32_bf16 v[216:219], a[160:163], v[114:117], v[216:219]
    v_mfma_f32_16x16x32_bf16 v[220:223], a[164:167], v[114:117], v[220:223]
    v_mfma_f32_16x16x32_bf16 v[224:227], a[168:171], v[114:117], v[224:227]
    v_mfma_f32_16x16x32_bf16 v[228:231], a[172:175], v[114:117], v[228:231]
    v_mfma_f32_16x16x32_bf16 v[232:235], a[176:179], v[114:117], v[232:235]
    buffer_load_dwordx4 v[114:117], v2, s[60:63], s68 offen offset:2048 sc1
    v_mfma_f32_16x16x32_bf16 v[236:239], a[160:163], v[118:121], v[236:239]
    v_mfma_f32_16x16x32_bf16 v[240:243], a[164:167], v[118:121], v[240:243]
    v_mfma_f32_16x16x32_bf16 v[244:247], a[168:171], v[118:121], v[244:247]
    v_mfma_f32_16x16x32_bf16 v[248:251], a[172:175], v[118:121], v[248:251]
    v_mfma_f32_16x16x32_bf16 v[252:255], a[176:179], v[118:121], v[252:255]
    buffer_load_dwordx4 v[118:121], v2, s[60:63], s68 offen offset:3072 sc1
    s_waitcnt vmcnt(35)
    v_mfma_f32_16x16x32_bf16 v[176:179], a[180:183], v[122:125], v[176:179]
    v_mfma_f32_16x16x32_bf16 v[180:183], a[184:187], v[122:125], v[180:183]
    buffer_load_dwordx4 a[56:59], v3, s[52:55], s71 offen sc1
    v_mfma_f32_16x16x32_bf16 v[184:187], a[188:191], v[122:125], v[184:187]
    v_mfma_f32_16x16x32_bf16 v[188:191], a[192:195], v[122:125], v[188:191]
    v_mfma_f32_16x16x32_bf16 v[192:195], a[196:199], v[122:125], v[192:195]
    s_mov_b32 s68, 61440
    buffer_load_dwordx4 v[122:125], v2, s[60:63], s68 offen offset:0 sc1
    v_mfma_f32_16x16x32_bf16 v[196:199], a[180:183], v[126:129], v[196:199]
    s_mov_b32 s71, 87040
    buffer_load_dwordx4 a[60:63], v2, s[52:55], s71 offen offset:0 sc1
    v_mfma_f32_16x16x32_bf16 v[200:203], a[184:187], v[126:129], v[200:203]
    v_mfma_f32_16x16x32_bf16 v[204:207], a[188:191], v[126:129], v[204:207]
    v_mfma_f32_16x16x32_bf16 v[208:211], a[192:195], v[126:129], v[208:211]
    v_mfma_f32_16x16x32_bf16 v[212:215], a[196:199], v[126:129], v[212:215]
    buffer_load_dwordx4 a[64:67], v2, s[52:55], s71 offen offset:1024 sc1
    buffer_load_dwordx4 v[126:129], v2, s[60:63], s68 offen offset:1024 sc1
    v_mfma_f32_16x16x32_bf16 v[216:219], a[180:183], v[130:133], v[216:219]
    v_mfma_f32_16x16x32_bf16 v[220:223], a[184:187], v[130:133], v[220:223]
    v_mfma_f32_16x16x32_bf16 v[224:227], a[188:191], v[130:133], v[224:227]
    v_mfma_f32_16x16x32_bf16 v[228:231], a[192:195], v[130:133], v[228:231]
    v_mfma_f32_16x16x32_bf16 v[232:235], a[196:199], v[130:133], v[232:235]
    buffer_load_dwordx4 v[130:133], v2, s[60:63], s68 offen offset:2048 sc1
    v_mfma_f32_16x16x32_bf16 v[236:239], a[180:183], v[134:137], v[236:239]
    v_mfma_f32_16x16x32_bf16 v[240:243], a[184:187], v[134:137], v[240:243]
    v_mfma_f32_16x16x32_bf16 v[244:247], a[188:191], v[134:137], v[244:247]
    v_mfma_f32_16x16x32_bf16 v[248:251], a[192:195], v[134:137], v[248:251]
    v_mfma_f32_16x16x32_bf16 v[252:255], a[196:199], v[134:137], v[252:255]
    buffer_load_dwordx4 v[134:137], v2, s[60:63], s68 offen offset:3072 sc1
    s_waitcnt vmcnt(35)
    v_mfma_f32_16x16x32_bf16 v[176:179], a[200:203], v[138:141], v[176:179]
    v_mfma_f32_16x16x32_bf16 v[180:183], a[204:207], v[138:141], v[180:183]
    buffer_load_dwordx4 a[68:71], v2, s[52:55], s71 offen offset:2048 sc1
    v_mfma_f32_16x16x32_bf16 v[184:187], a[208:211], v[138:141], v[184:187]
    v_mfma_f32_16x16x32_bf16 v[188:191], a[212:215], v[138:141], v[188:191]
    v_mfma_f32_16x16x32_bf16 v[192:195], a[216:219], v[138:141], v[192:195]
    s_mov_b32 s68, 65536
    buffer_load_dwordx4 v[138:141], v2, s[60:63], s68 offen offset:0 sc1
    v_mfma_f32_16x16x32_bf16 v[196:199], a[200:203], v[142:145], v[196:199]
    buffer_load_dwordx4 a[72:75], v2, s[52:55], s71 offen offset:3072 sc1
    v_mfma_f32_16x16x32_bf16 v[200:203], a[204:207], v[142:145], v[200:203]
    v_mfma_f32_16x16x32_bf16 v[204:207], a[208:211], v[142:145], v[204:207]
    v_mfma_f32_16x16x32_bf16 v[208:211], a[212:215], v[142:145], v[208:211]
    v_mfma_f32_16x16x32_bf16 v[212:215], a[216:219], v[142:145], v[212:215]
    buffer_load_dwordx4 a[76:79], v3, s[52:55], s71 offen sc1
    buffer_load_dwordx4 v[142:145], v2, s[60:63], s68 offen offset:1024 sc1
    v_mfma_f32_16x16x32_bf16 v[216:219], a[200:203], v[146:149], v[216:219]
    v_mfma_f32_16x16x32_bf16 v[220:223], a[204:207], v[146:149], v[220:223]
    v_mfma_f32_16x16x32_bf16 v[224:227], a[208:211], v[146:149], v[224:227]
    v_mfma_f32_16x16x32_bf16 v[228:231], a[212:215], v[146:149], v[228:231]
    v_mfma_f32_16x16x32_bf16 v[232:235], a[216:219], v[146:149], v[232:235]
    buffer_load_dwordx4 v[146:149], v2, s[60:63], s68 offen offset:2048 sc1
    v_mfma_f32_16x16x32_bf16 v[236:239], a[200:203], v[150:153], v[236:239]
    v_mfma_f32_16x16x32_bf16 v[240:243], a[204:207], v[150:153], v[240:243]
    v_mfma_f32_16x16x32_bf16 v[244:247], a[208:211], v[150:153], v[244:247]
    v_mfma_f32_16x16x32_bf16 v[248:251], a[212:215], v[150:153], v[248:251]
    v_mfma_f32_16x16x32_bf16 v[252:255], a[216:219], v[150:153], v[252:255]
    buffer_load_dwordx4 v[150:153], v2, s[60:63], s68 offen offset:3072 sc1
    s_waitcnt vmcnt(35)
    v_mfma_f32_16x16x32_bf16 v[176:179], a[220:223], v[154:157], v[176:179]
    s_mov_b32 s64, s20
    v_mfma_f32_16x16x32_bf16 v[180:183], a[224:227], v[154:157], v[180:183]
    s_mov_b32 s71, 92160
    buffer_load_dwordx4 a[80:83], v2, s[52:55], s71 offen offset:0 sc1
    s_mov_b32 s65, s21
    v_mfma_f32_16x16x32_bf16 v[184:187], a[228:231], v[154:157], v[184:187]
    s_mov_b32 s66, 1280
    v_mfma_f32_16x16x32_bf16 v[188:191], a[232:235], v[154:157], v[188:191]
    s_mov_b32 s67, 0x20000
    v_mfma_f32_16x16x32_bf16 v[192:195], a[236:239], v[154:157], v[192:195]
    s_mov_b32 s92, 0xffff0000
    s_mov_b32 s68, 69632
    buffer_load_dwordx4 v[154:157], v2, s[60:63], s68 offen offset:0 sc1
    v_mfma_f32_16x16x32_bf16 v[196:199], a[220:223], v[158:161], v[196:199]
    buffer_load_dwordx4 a[84:87], v2, s[52:55], s71 offen offset:1024 sc1
    v_add_u32 v172, 0, v1
    v_mfma_f32_16x16x32_bf16 v[200:203], a[224:227], v[158:161], v[200:203]
    v_mul_u32_u24 v173, 0xccd, v172
    v_mfma_f32_16x16x32_bf16 v[204:207], a[228:231], v[158:161], v[204:207]
    v_lshrrev_b32 v173, 16, v173
    v_mfma_f32_16x16x32_bf16 v[208:211], a[232:235], v[158:161], v[208:211]
    v_mul_u32_u24 v174, 20, v173
    v_mfma_f32_16x16x32_bf16 v[212:215], a[236:239], v[158:161], v[212:215]
    buffer_load_dwordx4 a[88:91], v2, s[52:55], s71 offen offset:2048 sc1
    v_sub_u32 v174, v172, v174
    buffer_load_dwordx4 v[158:161], v2, s[60:63], s68 offen offset:1024 sc1
    v_mfma_f32_16x16x32_bf16 v[216:219], a[220:223], v[162:165], v[216:219]
    s_lshl_b32 s43, s38, 4
    v_mfma_f32_16x16x32_bf16 v[220:223], a[224:227], v[162:165], v[220:223]
    v_add_u32 v173, s43, v173
    v_mfma_f32_16x16x32_bf16 v[224:227], a[228:231], v[162:165], v[224:227]
    v_mul_u32_u24 v175, 336, v173
    v_mfma_f32_16x16x32_bf16 v[228:231], a[232:235], v[162:165], v[228:231]
    v_lshl_add_u32 v40, v174, 4, v175
    v_mfma_f32_16x16x32_bf16 v[232:235], a[236:239], v[162:165], v[232:235]
    s_lshl_b32 s43, s22, 6
    buffer_load_dwordx4 v[162:165], v2, s[60:63], s68 offen offset:2048 sc1
    v_mfma_f32_16x16x32_bf16 v[236:239], a[220:223], v[166:169], v[236:239]
    v_add_u32 v173, s43, v173
    v_mfma_f32_16x16x32_bf16 v[240:243], a[224:227], v[166:169], v[240:243]
    s_mul_i32 s44, s23, 80
    v_mfma_f32_16x16x32_bf16 v[244:247], a[228:231], v[166:169], v[244:247]
    v_lshlrev_b32 v174, 2, v174
    v_mfma_f32_16x16x32_bf16 v[248:251], a[232:235], v[166:169], v[248:251]
    v_add_u32 v174, s44, v174
    v_mfma_f32_16x16x32_bf16 v[252:255], a[236:239], v[166:169], v[252:255]
    v_mul_u32_u24 v175, 640, v173
    buffer_load_dwordx4 v[166:169], v2, s[60:63], s68 offen offset:3072 sc1
    s_waitcnt vmcnt(35)
    v_mfma_f32_16x16x32_bf16 v[176:179], a[240:243], v[74:77], v[176:179]
    v_add_u32 v175, v175, v174
    v_mfma_f32_16x16x32_bf16 v[180:183], a[244:247], v[74:77], v[180:183]
    buffer_load_dwordx4 a[92:95], v2, s[52:55], s71 offen offset:3072 sc1
    v_lshlrev_b32 v35, 2, v175
    v_mfma_f32_16x16x32_bf16 v[184:187], a[248:251], v[74:77], v[184:187]
    v_lshlrev_b32 v175, 1, v175
    v_mfma_f32_16x16x32_bf16 v[188:191], a[252:255], v[74:77], v[188:191]
    v_mfma_f32_16x16x32_bf16 v[192:195], v[50:53], v[74:77], v[192:195]
    buffer_load_dwordx2 v[10:11], v175, s[48:51], 0 offen
    s_mov_b32 s68, 73728
    buffer_load_dwordx4 v[74:77], v2, s[60:63], s68 offen offset:0 sc1
    v_mfma_f32_16x16x32_bf16 v[196:199], a[240:243], v[78:81], v[196:199]
    buffer_load_dwordx4 a[96:99], v3, s[52:55], s71 offen sc1
    v_lshlrev_b32 v174, 1, v174
    v_mfma_f32_16x16x32_bf16 v[200:203], a[244:247], v[78:81], v[200:203]
    buffer_load_dwordx2 v[12:13], v174, s[64:67], 0 offen
    v_mfma_f32_16x16x32_bf16 v[204:207], a[248:251], v[78:81], v[204:207]
    v_lshlrev_b32 v173, 2, v173
    v_mfma_f32_16x16x32_bf16 v[208:211], a[252:255], v[78:81], v[208:211]
    v_add_u32 v45, 15138816, v173
    v_mfma_f32_16x16x32_bf16 v[212:215], v[50:53], v[78:81], v[212:215]
    s_mov_b32 s71, 97280
    buffer_load_dwordx4 a[100:103], v2, s[52:55], s71 offen offset:0 sc1
    v_add_u32 v172, 64, v1
    buffer_load_dwordx4 v[78:81], v2, s[60:63], s68 offen offset:1024 sc1
    v_mfma_f32_16x16x32_bf16 v[216:219], a[240:243], v[82:85], v[216:219]
    v_mul_u32_u24 v173, 0xccd, v172
    v_mfma_f32_16x16x32_bf16 v[220:223], a[244:247], v[82:85], v[220:223]
    v_lshrrev_b32 v173, 16, v173
    v_mfma_f32_16x16x32_bf16 v[224:227], a[248:251], v[82:85], v[224:227]
    v_mul_u32_u24 v174, 20, v173
    v_mfma_f32_16x16x32_bf16 v[228:231], a[252:255], v[82:85], v[228:231]
    v_sub_u32 v174, v172, v174
    v_mfma_f32_16x16x32_bf16 v[232:235], v[50:53], v[82:85], v[232:235]
    s_lshl_b32 s43, s38, 4
    buffer_load_dwordx4 v[82:85], v2, s[60:63], s68 offen offset:2048 sc1
    v_mfma_f32_16x16x32_bf16 v[236:239], a[240:243], v[86:89], v[236:239]
    v_add_u32 v173, s43, v173
    v_mfma_f32_16x16x32_bf16 v[240:243], a[244:247], v[86:89], v[240:243]
    v_mul_u32_u24 v175, 336, v173
    v_mfma_f32_16x16x32_bf16 v[244:247], a[248:251], v[86:89], v[244:247]
    v_lshl_add_u32 v41, v174, 4, v175
    v_mfma_f32_16x16x32_bf16 v[248:251], a[252:255], v[86:89], v[248:251]
    s_lshl_b32 s43, s22, 6
    v_mfma_f32_16x16x32_bf16 v[252:255], v[50:53], v[86:89], v[252:255]
    v_add_u32 v173, s43, v173
    buffer_load_dwordx4 v[86:89], v2, s[60:63], s68 offen offset:3072 sc1
    s_waitcnt vmcnt(37)
    v_mfma_f32_16x16x32_bf16 v[176:179], v[54:57], v[90:93], v[176:179]
    s_mul_i32 s44, s23, 80
    v_mfma_f32_16x16x32_bf16 v[180:183], v[58:61], v[90:93], v[180:183]
    buffer_load_dwordx4 a[104:107], v2, s[52:55], s71 offen offset:1024 sc1
    v_lshlrev_b32 v174, 2, v174
    v_mfma_f32_16x16x32_bf16 v[184:187], v[62:65], v[90:93], v[184:187]
    v_add_u32 v174, s44, v174
    v_mfma_f32_16x16x32_bf16 v[188:191], v[66:69], v[90:93], v[188:191]
    v_mul_u32_u24 v175, 640, v173
    v_mfma_f32_16x16x32_bf16 v[192:195], v[70:73], v[90:93], v[192:195]
    v_add_u32 v175, v175, v174
    s_mov_b32 s68, 77824
    buffer_load_dwordx4 v[90:93], v2, s[60:63], s68 offen offset:0 sc1
    v_mfma_f32_16x16x32_bf16 v[196:199], v[54:57], v[94:97], v[196:199]
    buffer_load_dwordx4 a[108:111], v2, s[52:55], s71 offen offset:2048 sc1
    v_lshlrev_b32 v36, 2, v175
    v_mfma_f32_16x16x32_bf16 v[200:203], v[58:61], v[94:97], v[200:203]
    v_mfma_f32_16x16x32_bf16 v[204:207], v[62:65], v[94:97], v[204:207]
    v_lshlrev_b32 v175, 1, v175
    v_mfma_f32_16x16x32_bf16 v[208:211], v[66:69], v[94:97], v[208:211]
    buffer_load_dwordx2 v[14:15], v175, s[48:51], 0 offen
    v_mfma_f32_16x16x32_bf16 v[212:215], v[70:73], v[94:97], v[212:215]
    buffer_load_dwordx4 a[112:115], v2, s[52:55], s71 offen offset:3072 sc1
    v_lshlrev_b32 v174, 1, v174
    buffer_load_dwordx4 v[94:97], v2, s[60:63], s68 offen offset:1024 sc1
    v_mfma_f32_16x16x32_bf16 v[216:219], v[54:57], v[98:101], v[216:219]
    buffer_load_dwordx2 v[16:17], v174, s[64:67], 0 offen
    v_mfma_f32_16x16x32_bf16 v[220:223], v[58:61], v[98:101], v[220:223]
    v_lshlrev_b32 v173, 2, v173
    v_mfma_f32_16x16x32_bf16 v[224:227], v[62:65], v[98:101], v[224:227]
    v_add_u32 v46, 15138816, v173
    v_mfma_f32_16x16x32_bf16 v[228:231], v[66:69], v[98:101], v[228:231]
    v_add_u32 v172, 128, v1
    v_mfma_f32_16x16x32_bf16 v[232:235], v[70:73], v[98:101], v[232:235]
    v_mul_u32_u24 v173, 0xccd, v172
    buffer_load_dwordx4 v[98:101], v2, s[60:63], s68 offen offset:2048 sc1
    v_mfma_f32_16x16x32_bf16 v[236:239], v[54:57], v[102:105], v[236:239]
    v_lshrrev_b32 v173, 16, v173
    v_mfma_f32_16x16x32_bf16 v[240:243], v[58:61], v[102:105], v[240:243]
    v_mul_u32_u24 v174, 20, v173
    v_mfma_f32_16x16x32_bf16 v[244:247], v[62:65], v[102:105], v[244:247]
    v_sub_u32 v174, v172, v174
    v_mfma_f32_16x16x32_bf16 v[248:251], v[66:69], v[102:105], v[248:251]
    s_lshl_b32 s43, s38, 4
    v_mfma_f32_16x16x32_bf16 v[252:255], v[70:73], v[102:105], v[252:255]
    v_add_u32 v173, s43, v173
    buffer_load_dwordx4 v[102:105], v2, s[60:63], s68 offen offset:3072 sc1
    s_waitcnt vmcnt(39)
    v_mfma_f32_16x16x32_bf16 v[176:179], a[0:3], v[106:109], v[176:179]
    v_mul_u32_u24 v175, 336, v173
    v_mfma_f32_16x16x32_bf16 v[180:183], a[4:7], v[106:109], v[180:183]
    buffer_load_dwordx4 a[116:119], v3, s[52:55], s71 offen sc1
    v_lshl_add_u32 v42, v174, 4, v175
    v_mfma_f32_16x16x32_bf16 v[184:187], a[8:11], v[106:109], v[184:187]
    s_lshl_b32 s43, s22, 6
    v_mfma_f32_16x16x32_bf16 v[188:191], a[12:15], v[106:109], v[188:191]
    v_add_u32 v173, s43, v173
    v_mfma_f32_16x16x32_bf16 v[192:195], a[16:19], v[106:109], v[192:195]
    s_mul_i32 s44, s23, 80
    s_mov_b32 s68, 81920
    buffer_load_dwordx4 v[106:109], v2, s[60:63], s68 offen offset:0 sc1
    v_mfma_f32_16x16x32_bf16 v[196:199], a[0:3], v[110:113], v[196:199]
    s_mov_b32 s71, 102400
    buffer_load_dwordx4 a[120:123], v2, s[52:55], s71 offen offset:0 sc1
    v_lshlrev_b32 v174, 2, v174
    v_mfma_f32_16x16x32_bf16 v[200:203], a[4:7], v[110:113], v[200:203]
    v_add_u32 v174, s44, v174
    v_mfma_f32_16x16x32_bf16 v[204:207], a[8:11], v[110:113], v[204:207]
    v_mul_u32_u24 v175, 640, v173
    v_mfma_f32_16x16x32_bf16 v[208:211], a[12:15], v[110:113], v[208:211]
    v_add_u32 v175, v175, v174
    v_mfma_f32_16x16x32_bf16 v[212:215], a[16:19], v[110:113], v[212:215]
    buffer_load_dwordx4 a[124:127], v2, s[52:55], s71 offen offset:1024 sc1
    buffer_load_dwordx4 v[110:113], v2, s[60:63], s68 offen offset:1024 sc1
    v_mfma_f32_16x16x32_bf16 v[216:219], a[0:3], v[114:117], v[216:219]
    v_lshlrev_b32 v37, 2, v175
    v_mfma_f32_16x16x32_bf16 v[220:223], a[4:7], v[114:117], v[220:223]
    v_lshlrev_b32 v175, 1, v175
    v_mfma_f32_16x16x32_bf16 v[224:227], a[8:11], v[114:117], v[224:227]
    buffer_load_dwordx2 v[18:19], v175, s[48:51], 0 offen
    v_mfma_f32_16x16x32_bf16 v[228:231], a[12:15], v[114:117], v[228:231]
    v_lshlrev_b32 v174, 1, v174
    v_mfma_f32_16x16x32_bf16 v[232:235], a[16:19], v[114:117], v[232:235]
    buffer_load_dwordx2 v[20:21], v174, s[64:67], 0 offen
    buffer_load_dwordx4 v[114:117], v2, s[60:63], s68 offen offset:2048 sc1
    v_mfma_f32_16x16x32_bf16 v[236:239], a[0:3], v[118:121], v[236:239]
    v_lshlrev_b32 v173, 2, v173
    v_mfma_f32_16x16x32_bf16 v[240:243], a[4:7], v[118:121], v[240:243]
    v_add_u32 v47, 15138816, v173
    v_mfma_f32_16x16x32_bf16 v[244:247], a[8:11], v[118:121], v[244:247]
    v_add_u32 v172, 192, v1
    v_mfma_f32_16x16x32_bf16 v[248:251], a[12:15], v[118:121], v[248:251]
    v_mul_u32_u24 v173, 0xccd, v172
    v_mfma_f32_16x16x32_bf16 v[252:255], a[16:19], v[118:121], v[252:255]
    v_lshrrev_b32 v173, 16, v173
    buffer_load_dwordx4 v[118:121], v2, s[60:63], s68 offen offset:3072 sc1
    s_waitcnt vmcnt(41)
    v_mfma_f32_16x16x32_bf16 v[176:179], a[20:23], v[122:125], v[176:179]
    v_mul_u32_u24 v174, 20, v173
    v_mfma_f32_16x16x32_bf16 v[180:183], a[24:27], v[122:125], v[180:183]
    buffer_load_dwordx4 a[128:131], v2, s[52:55], s71 offen offset:2048 sc1
    v_sub_u32 v174, v172, v174
    v_mfma_f32_16x16x32_bf16 v[184:187], a[28:31], v[122:125], v[184:187]
    s_lshl_b32 s43, s38, 4
    v_mfma_f32_16x16x32_bf16 v[188:191], a[32:35], v[122:125], v[188:191]
    v_add_u32 v173, s43, v173
    v_mfma_f32_16x16x32_bf16 v[192:195], a[36:39], v[122:125], v[192:195]
    v_mul_u32_u24 v175, 336, v173
    s_mov_b32 s68, 86016
    buffer_load_dwordx4 v[122:125], v2, s[60:63], s68 offen offset:0 sc1
    v_mfma_f32_16x16x32_bf16 v[196:199], a[20:23], v[126:129], v[196:199]
    buffer_load_dwordx4 a[132:135], v2, s[52:55], s71 offen offset:3072 sc1
    v_lshl_add_u32 v43, v174, 4, v175
    v_mfma_f32_16x16x32_bf16 v[200:203], a[24:27], v[126:129], v[200:203]
    s_lshl_b32 s43, s22, 6
    v_mfma_f32_16x16x32_bf16 v[204:207], a[28:31], v[126:129], v[204:207]
    v_add_u32 v173, s43, v173
    v_mfma_f32_16x16x32_bf16 v[208:211], a[32:35], v[126:129], v[208:211]
    s_mul_i32 s44, s23, 80
    v_mfma_f32_16x16x32_bf16 v[212:215], a[36:39], v[126:129], v[212:215]
    buffer_load_dwordx4 a[136:139], v3, s[52:55], s71 offen sc1
    v_lshlrev_b32 v174, 2, v174
    buffer_load_dwordx4 v[126:129], v2, s[60:63], s68 offen offset:1024 sc1
    v_mfma_f32_16x16x32_bf16 v[216:219], a[20:23], v[130:133], v[216:219]
    v_add_u32 v174, s44, v174
    v_mfma_f32_16x16x32_bf16 v[220:223], a[24:27], v[130:133], v[220:223]
    v_mul_u32_u24 v175, 640, v173
    v_mfma_f32_16x16x32_bf16 v[224:227], a[28:31], v[130:133], v[224:227]
    v_add_u32 v175, v175, v174
    v_mfma_f32_16x16x32_bf16 v[228:231], a[32:35], v[130:133], v[228:231]
    v_mfma_f32_16x16x32_bf16 v[232:235], a[36:39], v[130:133], v[232:235]
    v_lshlrev_b32 v38, 2, v175
    buffer_load_dwordx4 v[130:133], v2, s[60:63], s68 offen offset:2048 sc1
    v_mfma_f32_16x16x32_bf16 v[236:239], a[20:23], v[134:137], v[236:239]
    v_lshlrev_b32 v175, 1, v175
    v_mfma_f32_16x16x32_bf16 v[240:243], a[24:27], v[134:137], v[240:243]
    buffer_load_dwordx2 v[22:23], v175, s[48:51], 0 offen
    v_mfma_f32_16x16x32_bf16 v[244:247], a[28:31], v[134:137], v[244:247]
    v_lshlrev_b32 v174, 1, v174
    v_mfma_f32_16x16x32_bf16 v[248:251], a[32:35], v[134:137], v[248:251]
    buffer_load_dwordx2 v[24:25], v174, s[64:67], 0 offen
    v_mfma_f32_16x16x32_bf16 v[252:255], a[36:39], v[134:137], v[252:255]
    v_lshlrev_b32 v173, 2, v173
    buffer_load_dwordx4 v[134:137], v2, s[60:63], s68 offen offset:3072 sc1
    s_waitcnt vmcnt(43)
    v_mfma_f32_16x16x32_bf16 v[176:179], a[40:43], v[138:141], v[176:179]
    v_add_u32 v48, 15138816, v173
    v_mfma_f32_16x16x32_bf16 v[180:183], a[44:47], v[138:141], v[180:183]
    s_mov_b32 s71, 107520
    buffer_load_dwordx4 a[140:143], v2, s[52:55], s71 offen offset:0 sc1
    v_add_u32 v172, 256, v1
    v_mfma_f32_16x16x32_bf16 v[184:187], a[48:51], v[138:141], v[184:187]
    v_mul_u32_u24 v173, 0xccd, v172
    v_mfma_f32_16x16x32_bf16 v[188:191], a[52:55], v[138:141], v[188:191]
    v_lshrrev_b32 v173, 16, v173
    v_mfma_f32_16x16x32_bf16 v[192:195], a[56:59], v[138:141], v[192:195]
    v_mul_u32_u24 v174, 20, v173
    v_mfma_f32_16x16x32_bf16 v[196:199], a[40:43], v[142:145], v[196:199]
    buffer_load_dwordx4 a[144:147], v2, s[52:55], s71 offen offset:1024 sc1
    v_sub_u32 v174, v172, v174
    v_mfma_f32_16x16x32_bf16 v[200:203], a[44:47], v[142:145], v[200:203]
    s_lshl_b32 s43, s38, 4
    v_mfma_f32_16x16x32_bf16 v[204:207], a[48:51], v[142:145], v[204:207]
    v_add_u32 v173, s43, v173
    v_mfma_f32_16x16x32_bf16 v[208:211], a[52:55], v[142:145], v[208:211]
    v_mul_u32_u24 v175, 336, v173
    v_mfma_f32_16x16x32_bf16 v[212:215], a[56:59], v[142:145], v[212:215]
    buffer_load_dwordx4 a[148:151], v2, s[52:55], s71 offen offset:2048 sc1
    v_lshl_add_u32 v44, v174, 4, v175
    v_mfma_f32_16x16x32_bf16 v[216:219], a[40:43], v[146:149], v[216:219]
    s_lshl_b32 s43, s22, 6
    v_mfma_f32_16x16x32_bf16 v[220:223], a[44:47], v[146:149], v[220:223]
    v_add_u32 v173, s43, v173
    v_mfma_f32_16x16x32_bf16 v[224:227], a[48:51], v[146:149], v[224:227]
    s_mul_i32 s44, s23, 80
    v_mfma_f32_16x16x32_bf16 v[228:231], a[52:55], v[146:149], v[228:231]
    v_lshlrev_b32 v174, 2, v174
    v_mfma_f32_16x16x32_bf16 v[232:235], a[56:59], v[146:149], v[232:235]
    v_add_u32 v174, s44, v174
    v_mfma_f32_16x16x32_bf16 v[236:239], a[40:43], v[150:153], v[236:239]
    v_mul_u32_u24 v175, 640, v173
    v_mfma_f32_16x16x32_bf16 v[240:243], a[44:47], v[150:153], v[240:243]
    v_mfma_f32_16x16x32_bf16 v[244:247], a[48:51], v[150:153], v[244:247]
    v_add_u32 v175, v175, v174
    v_mfma_f32_16x16x32_bf16 v[248:251], a[52:55], v[150:153], v[248:251]
    v_lshlrev_b32 v39, 2, v175
    v_mfma_f32_16x16x32_bf16 v[252:255], a[56:59], v[150:153], v[252:255]
    v_lshlrev_b32 v175, 1, v175
    s_waitcnt vmcnt(39)
    v_mfma_f32_16x16x32_bf16 v[176:179], a[60:63], v[154:157], v[176:179]
    buffer_load_dwordx2 v[26:27], v175, s[48:51], 0 offen
    v_mfma_f32_16x16x32_bf16 v[180:183], a[64:67], v[154:157], v[180:183]
    buffer_load_dwordx4 a[152:155], v2, s[52:55], s71 offen offset:3072 sc1
    v_lshlrev_b32 v174, 1, v174
    v_mfma_f32_16x16x32_bf16 v[184:187], a[68:71], v[154:157], v[184:187]
    buffer_load_dwordx2 v[28:29], v174, s[64:67], 0 offen
    v_mfma_f32_16x16x32_bf16 v[188:191], a[72:75], v[154:157], v[188:191]
    v_lshlrev_b32 v173, 2, v173
    v_mfma_f32_16x16x32_bf16 v[192:195], a[76:79], v[154:157], v[192:195]
    v_add_u32 v49, 15138816, v173
    v_mfma_f32_16x16x32_bf16 v[196:199], a[60:63], v[158:161], v[196:199]
    buffer_load_dwordx4 a[156:159], v3, s[52:55], s71 offen sc1
    buffer_load_dword v30, v45, s[56:59], 0 offen sc1
    v_mfma_f32_16x16x32_bf16 v[200:203], a[64:67], v[158:161], v[200:203]
    buffer_load_dword v31, v46, s[56:59], 0 offen sc1
    v_mfma_f32_16x16x32_bf16 v[204:207], a[68:71], v[158:161], v[204:207]
    buffer_load_dword v32, v47, s[56:59], 0 offen sc1
    v_mfma_f32_16x16x32_bf16 v[208:211], a[72:75], v[158:161], v[208:211]
    buffer_load_dword v33, v48, s[56:59], 0 offen sc1
    v_mfma_f32_16x16x32_bf16 v[212:215], a[76:79], v[158:161], v[212:215]
    buffer_load_dword v34, v49, s[56:59], 0 offen sc1
    v_mfma_f32_16x16x32_bf16 v[216:219], a[60:63], v[162:165], v[216:219]
    v_and_b32 v4, 15, v1
    v_mfma_f32_16x16x32_bf16 v[220:223], a[64:67], v[162:165], v[220:223]
    v_mul_u32_u24 v4, 336, v4
    v_mfma_f32_16x16x32_bf16 v[224:227], a[68:71], v[162:165], v[224:227]
    v_lshrrev_b32 v5, 4, v1
    v_mfma_f32_16x16x32_bf16 v[228:231], a[72:75], v[162:165], v[228:231]
    v_lshl_add_u32 v4, v5, 4, v4
    v_mfma_f32_16x16x32_bf16 v[232:235], a[76:79], v[162:165], v[232:235]
    v_add_u32 v5, 21504, v4
    v_mfma_f32_16x16x32_bf16 v[236:239], a[60:63], v[166:169], v[236:239]
    s_add_u32 s41, s38, 1
    v_mfma_f32_16x16x32_bf16 v[240:243], a[64:67], v[166:169], v[240:243]
    s_cmp_eq_u32 s38, 0
    s_cselect_b32 s41, 0, s41
    v_mfma_f32_16x16x32_bf16 v[244:247], a[68:71], v[166:169], v[244:247]
    s_mul_i32 s41, s41, 21504
    v_mfma_f32_16x16x32_bf16 v[248:251], a[72:75], v[166:169], v[248:251]
    v_add_u32 v4, s41, v4
    v_mfma_f32_16x16x32_bf16 v[252:255], a[76:79], v[166:169], v[252:255]
    s_waitcnt vmcnt(39)
    s_cmp_lg_u32 s38, 1
    s_cbranch_scc1 L_p2_nodump
    s_nop 7
    ds_write_b128 v5, v[176:179] offset:0
    ds_write_b128 v5, v[180:183] offset:64
    ds_write_b128 v5, v[184:187] offset:128
    ds_write_b128 v5, v[188:191] offset:192
    ds_write_b128 v5, v[192:195] offset:256
    ds_write_b128 v5, v[196:199] offset:5376
    v_mfma_f32_16x16x32_bf16 v[176:179], a[80:83], v[74:77], 0
    ds_write_b128 v5, v[200:203] offset:5440
    v_mfma_f32_16x16x32_bf16 v[180:183], a[84:87], v[74:77], 0
    ds_write_b128 v5, v[204:207] offset:5504
    v_mfma_f32_16x16x32_bf16 v[184:187], a[88:91], v[74:77], 0
    ds_write_b128 v5, v[208:211] offset:5568
    v_mfma_f32_16x16x32_bf16 v[188:191], a[92:95], v[74:77], 0
    ds_write_b128 v5, v[212:215] offset:5632
    v_mfma_f32_16x16x32_bf16 v[192:195], a[96:99], v[74:77], 0
    ds_write_b128 v5, v[216:219] offset:10752
    v_mfma_f32_16x16x32_bf16 v[196:199], a[80:83], v[78:81], 0
    ds_write_b128 v5, v[220:223] offset:10816
    v_mfma_f32_16x16x32_bf16 v[200:203], a[84:87], v[78:81], 0
    ds_write_b128 v5, v[224:227] offset:10880
    v_mfma_f32_16x16x32_bf16 v[204:207], a[88:91], v[78:81], 0
    ds_write_b128 v5, v[228:231] offset:10944
    v_mfma_f32_16x16x32_bf16 v[208:211], a[92:95], v[78:81], 0
    ds_write_b128 v5, v[232:235] offset:11008
    v_mfma_f32_16x16x32_bf16 v[212:215], a[96:99], v[78:81], 0
    ds_write_b128 v5, v[236:239] offset:16128
    v_mfma_f32_16x16x32_bf16 v[216:219], a[80:83], v[82:85], 0
    ds_write_b128 v5, v[240:243] offset:16192
    v_mfma_f32_16x16x32_bf16 v[220:223], a[84:87], v[82:85], 0
    ds_write_b128 v5, v[244:247] offset:16256
    v_mfma_f32_16x16x32_bf16 v[224:227], a[88:91], v[82:85], 0
    ds_write_b128 v5, v[248:251] offset:16320
    v_mfma_f32_16x16x32_bf16 v[228:231], a[92:95], v[82:85], 0
    ds_write_b128 v5, v[252:255] offset:16384
    v_mfma_f32_16x16x32_bf16 v[232:235], a[96:99], v[82:85], 0
    v_mfma_f32_16x16x32_bf16 v[236:239], a[80:83], v[86:89], 0
    v_mfma_f32_16x16x32_bf16 v[240:243], a[84:87], v[86:89], 0
    v_mfma_f32_16x16x32_bf16 v[244:247], a[88:91], v[86:89], 0
    v_mfma_f32_16x16x32_bf16 v[248:251], a[92:95], v[86:89], 0
    v_mfma_f32_16x16x32_bf16 v[252:255], a[96:99], v[86:89], 0
    s_branch L_p2_dumped
L_p2_nodump:
    v_mfma_f32_16x16x32_bf16 v[176:179], a[80:83], v[74:77], v[176:179]
    v_mfma_f32_16x16x32_bf16 v[180:183], a[84:87], v[74:77], v[180:183]
    v_mfma_f32_16x16x32_bf16 v[184:187], a[88:91], v[74:77], v[184:187]
    v_mfma_f32_16x16x32_bf16 v[188:191], a[92:95], v[74:77], v[188:191]
    v_mfma_f32_16x16x32_bf16 v[192:195], a[96:99], v[74:77], v[192:195]
    v_mfma_f32_16x16x32_bf16 v[196:199], a[80:83], v[78:81], v[196:199]
    v_mfma_f32_16x16x32_bf16 v[200:203], a[84:87], v[78:81], v[200:203]
    v_mfma_f32_16x16x32_bf16 v[204:207], a[88:91], v[78:81], v[204:207]
    v_mfma_f32_16x16x32_bf16 v[208:211], a[92:95], v[78:81], v[208:211]
    v_mfma_f32_16x16x32_bf16 v[212:215], a[96:99], v[78:81], v[212:215]
    v_mfma_f32_16x16x32_bf16 v[216:219], a[80:83], v[82:85], v[216:219]
    v_mfma_f32_16x16x32_bf16 v[220:223], a[84:87], v[82:85], v[220:223]
    v_mfma_f32_16x16x32_bf16 v[224:227], a[88:91], v[82:85], v[224:227]
    v_mfma_f32_16x16x32_bf16 v[228:231], a[92:95], v[82:85], v[228:231]
    v_mfma_f32_16x16x32_bf16 v[232:235], a[96:99], v[82:85], v[232:235]
    v_mfma_f32_16x16x32_bf16 v[236:239], a[80:83], v[86:89], v[236:239]
    v_mfma_f32_16x16x32_bf16 v[240:243], a[84:87], v[86:89], v[240:243]
    v_mfma_f32_16x16x32_bf16 v[244:247], a[88:91], v[86:89], v[244:247]
    v_mfma_f32_16x16x32_bf16 v[248:251], a[92:95], v[86:89], v[248:251]
    v_mfma_f32_16x16x32_bf16 v[252:255], a[96:99], v[86:89], v[252:255]
L_p2_dumped:
    s_waitcnt vmcnt(29)
    v_mfma_f32_16x16x32_bf16 v[176:179], a[100:103], v[90:93], v[176:179]
    s_waitcnt vmcnt(6)
    v_lshlrev_b32 v172, 16, v10
    v_mfma_f32_16x16x32_bf16 v[180:183], a[104:107], v[90:93], v[180:183]
    v_and_b32 v173, s92, v10
    v_lshlrev_b32 v174, 16, v12
    v_mfma_f32_16x16x32_bf16 v[184:187], a[108:111], v[90:93], v[184:187]
    v_and_b32 v175, s92, v12
    v_mfma_f32_16x16x32_bf16 v[188:191], a[112:115], v[90:93], v[188:191]
    v_mul_f32 v172, v172, v174
    v_mul_f32 v173, v173, v175
    v_mfma_f32_16x16x32_bf16 v[192:195], a[116:119], v[90:93], v[192:195]
    v_cvt_pk_bf16_f32 v6, v172, v173
    v_mfma_f32_16x16x32_bf16 v[196:199], a[100:103], v[94:97], v[196:199]
    v_lshlrev_b32 v172, 16, v11
    v_and_b32 v173, s92, v11
    v_mfma_f32_16x16x32_bf16 v[200:203], a[104:107], v[94:97], v[200:203]
    v_lshlrev_b32 v174, 16, v13
    v_mfma_f32_16x16x32_bf16 v[204:207], a[108:111], v[94:97], v[204:207]
    v_and_b32 v175, s92, v13
    v_mul_f32 v172, v172, v174
    v_mfma_f32_16x16x32_bf16 v[208:211], a[112:115], v[94:97], v[208:211]
    v_mul_f32 v173, v173, v175
    v_mfma_f32_16x16x32_bf16 v[212:215], a[116:119], v[94:97], v[212:215]
    v_cvt_pk_bf16_f32 v7, v172, v173
    v_and_b32 v11, s92, v6
    v_mfma_f32_16x16x32_bf16 v[216:219], a[100:103], v[98:101], v[216:219]
    v_lshlrev_b32 v10, 16, v6
    v_mfma_f32_16x16x32_bf16 v[220:223], a[104:107], v[98:101], v[220:223]
    v_and_b32 v13, s92, v7
    v_lshlrev_b32 v12, 16, v7
    v_mfma_f32_16x16x32_bf16 v[224:227], a[108:111], v[98:101], v[224:227]
    v_lshlrev_b32 v172, 16, v14
    v_mfma_f32_16x16x32_bf16 v[228:231], a[112:115], v[98:101], v[228:231]
    v_and_b32 v173, s92, v14
    v_lshlrev_b32 v174, 16, v16
    v_mfma_f32_16x16x32_bf16 v[232:235], a[116:119], v[98:101], v[232:235]
    v_and_b32 v175, s92, v16
    v_mfma_f32_16x16x32_bf16 v[236:239], a[100:103], v[102:105], v[236:239]
    v_mul_f32 v172, v172, v174
    v_mul_f32 v173, v173, v175
    v_mfma_f32_16x16x32_bf16 v[240:243], a[104:107], v[102:105], v[240:243]
    v_cvt_pk_bf16_f32 v6, v172, v173
    v_mfma_f32_16x16x32_bf16 v[244:247], a[108:111], v[102:105], v[244:247]
    v_lshlrev_b32 v172, 16, v15
    v_and_b32 v173, s92, v15
    v_mfma_f32_16x16x32_bf16 v[248:251], a[112:115], v[102:105], v[248:251]
    v_lshlrev_b32 v174, 16, v17
    v_mfma_f32_16x16x32_bf16 v[252:255], a[116:119], v[102:105], v[252:255]
    v_and_b32 v175, s92, v17
    v_mul_f32 v172, v172, v174
    v_mfma_f32_16x16x32_bf16 v[176:179], a[120:123], v[106:109], v[176:179]
    v_mul_f32 v173, v173, v175
    v_mfma_f32_16x16x32_bf16 v[180:183], a[124:127], v[106:109], v[180:183]
    v_cvt_pk_bf16_f32 v7, v172, v173
    v_and_b32 v15, s92, v6
    v_mfma_f32_16x16x32_bf16 v[184:187], a[128:131], v[106:109], v[184:187]
    v_lshlrev_b32 v14, 16, v6
    v_mfma_f32_16x16x32_bf16 v[188:191], a[132:135], v[106:109], v[188:191]
    v_and_b32 v17, s92, v7
    v_lshlrev_b32 v16, 16, v7
    v_mfma_f32_16x16x32_bf16 v[192:195], a[136:139], v[106:109], v[192:195]
    v_lshlrev_b32 v172, 16, v18
    v_mfma_f32_16x16x32_bf16 v[196:199], a[120:123], v[110:113], v[196:199]
    v_and_b32 v173, s92, v18
    v_lshlrev_b32 v174, 16, v20
    v_mfma_f32_16x16x32_bf16 v[200:203], a[124:127], v[110:113], v[200:203]
    v_and_b32 v175, s92, v20
    v_mfma_f32_16x16x32_bf16 v[204:207], a[128:131], v[110:113], v[204:207]
    v_mul_f32 v172, v172, v174
    v_mul_f32 v173, v173, v175
    v_mfma_f32_16x16x32_bf16 v[208:211], a[132:135], v[110:113], v[208:211]
    v_cvt_pk_bf16_f32 v6, v172, v173
    v_mfma_f32_16x16x32_bf16 v[212:215], a[136:139], v[110:113], v[212:215]
    v_lshlrev_b32 v172, 16, v19
    v_and_b32 v173, s92, v19
    v_mfma_f32_16x16x32_bf16 v[216:219], a[120:123], v[114:117], v[216:219]
    v_lshlrev_b32 v174, 16, v21
    v_and_b32 v175, s92, v21
    v_mfma_f32_16x16x32_bf16 v[220:223], a[124:127], v[114:117], v[220:223]
    v_mul_f32 v172, v172, v174
    v_mfma_f32_16x16x32_bf16 v[224:227], a[128:131], v[114:117], v[224:227]
    v_mul_f32 v173, v173, v175
    v_cvt_pk_bf16_f32 v7, v172, v173
    v_mfma_f32_16x16x32_bf16 v[228:231], a[132:135], v[114:117], v[228:231]
    v_and_b32 v19, s92, v6
    v_mfma_f32_16x16x32_bf16 v[232:235], a[136:139], v[114:117], v[232:235]
    v_lshlrev_b32 v18, 16, v6
    v_and_b32 v21, s92, v7
    v_mfma_f32_16x16x32_bf16 v[236:239], a[120:123], v[118:121], v[236:239]
    v_lshlrev_b32 v20, 16, v7
    v_mfma_f32_16x16x32_bf16 v[240:243], a[124:127], v[118:121], v[240:243]
    v_lshlrev_b32 v172, 16, v22
    v_and_b32 v173, s92, v22
    v_mfma_f32_16x16x32_bf16 v[244:247], a[128:131], v[118:121], v[244:247]
    v_lshlrev_b32 v174, 16, v24
    v_mfma_f32_16x16x32_bf16 v[248:251], a[132:135], v[118:121], v[248:251]
    v_and_b32 v175, s92, v24
    v_mul_f32 v172, v172, v174
    v_mfma_f32_16x16x32_bf16 v[252:255], a[136:139], v[118:121], v[252:255]
    v_mul_f32 v173, v173, v175
    s_waitcnt vmcnt(5)
    v_mfma_f32_16x16x32_bf16 v[176:179], a[140:143], v[122:125], v[176:179]
    v_cvt_pk_bf16_f32 v6, v172, v173
    v_lshlrev_b32 v172, 16, v23
    v_mfma_f32_16x16x32_bf16 v[180:183], a[144:147], v[122:125], v[180:183]
    v_and_b32 v173, s92, v23
    v_mfma_f32_16x16x32_bf16 v[184:187], a[148:151], v[122:125], v[184:187]
    v_lshlrev_b32 v174, 16, v25
    v_and_b32 v175, s92, v25
    v_mfma_f32_16x16x32_bf16 v[188:191], a[152:155], v[122:125], v[188:191]
    v_mul_f32 v172, v172, v174
    v_mfma_f32_16x16x32_bf16 v[192:195], a[156:159], v[122:125], v[192:195]
    v_mul_f32 v173, v173, v175
    v_cvt_pk_bf16_f32 v7, v172, v173
    v_mfma_f32_16x16x32_bf16 v[196:199], a[140:143], v[126:129], v[196:199]
    ds_write_b128 v4, v[176:179] offset:0
    v_and_b32 v23, s92, v6
    v_mfma_f32_16x16x32_bf16 v[200:203], a[144:147], v[126:129], v[200:203]
    ds_write_b128 v4, v[180:183] offset:64
    v_lshlrev_b32 v22, 16, v6
    v_and_b32 v25, s92, v7
    v_mfma_f32_16x16x32_bf16 v[204:207], a[148:151], v[126:129], v[204:207]
    ds_write_b128 v4, v[184:187] offset:128
    v_lshlrev_b32 v24, 16, v7
    v_mfma_f32_16x16x32_bf16 v[208:211], a[152:155], v[126:129], v[208:211]
    ds_write_b128 v4, v[188:191] offset:192
    v_lshlrev_b32 v172, 16, v26
    v_and_b32 v173, s92, v26
    v_mfma_f32_16x16x32_bf16 v[212:215], a[156:159], v[126:129], v[212:215]
    ds_write_b128 v4, v[192:195] offset:256
    v_lshlrev_b32 v174, 16, v28
    v_mfma_f32_16x16x32_bf16 v[216:219], a[140:143], v[130:133], v[216:219]
    ds_write_b128 v4, v[196:199] offset:5376
    v_and_b32 v175, s92, v28
    v_mul_f32 v172, v172, v174
    v_mfma_f32_16x16x32_bf16 v[220:223], a[144:147], v[130:133], v[220:223]
    ds_write_b128 v4, v[200:203] offset:5440
    v_mul_f32 v173, v173, v175
    v_mfma_f32_16x16x32_bf16 v[224:227], a[148:151], v[130:133], v[224:227]
    ds_write_b128 v4, v[204:207] offset:5504
    v_cvt_pk_bf16_f32 v6, v172, v173
    v_lshlrev_b32 v172, 16, v27
    v_mfma_f32_16x16x32_bf16 v[228:231], a[152:155], v[130:133], v[228:231]
    ds_write_b128 v4, v[208:211] offset:5568
    v_and_b32 v173, s92, v27
    v_mfma_f32_16x16x32_bf16 v[232:235], a[156:159], v[130:133], v[232:235]
    ds_write_b128 v4, v[212:215] offset:5632
    v_lshlrev_b32 v174, 16, v29
    v_and_b32 v175, s92, v29
    v_mfma_f32_16x16x32_bf16 v[236:239], a[140:143], v[134:137], v[236:239]
    ds_write_b128 v4, v[216:219] offset:10752
    v_mul_f32 v172, v172, v174
    v_mfma_f32_16x16x32_bf16 v[240:243], a[144:147], v[134:137], v[240:243]
    ds_write_b128 v4, v[220:223] offset:10816
    v_mul_f32 v173, v173, v175
    v_cvt_pk_bf16_f32 v7, v172, v173
    v_mfma_f32_16x16x32_bf16 v[244:247], a[148:151], v[134:137], v[244:247]
    ds_write_b128 v4, v[224:227] offset:10880
    v_and_b32 v27, s92, v6
    v_mfma_f32_16x16x32_bf16 v[248:251], a[152:155], v[134:137], v[248:251]
    ds_write_b128 v4, v[228:231] offset:10944
    v_lshlrev_b32 v26, 16, v6
    v_and_b32 v29, s92, v7
    v_mfma_f32_16x16x32_bf16 v[252:255], a[156:159], v[134:137], v[252:255]
    ds_write_b128 v4, v[232:235] offset:11008
    v_lshlrev_b32 v28, 16, v7
    s_nop 3
    ds_write_b128 v4, v[236:239] offset:16128
    ds_write_b128 v4, v[240:243] offset:16192
    ds_write_b128 v4, v[244:247] offset:16256
    ds_write_b128 v4, v[248:251] offset:16320
    ds_write_b128 v4, v[252:255] offset:16384
    s_waitcnt vmcnt(0) lgkmcnt(0)
    s_barrier
    s_mov_b32 s60, s30
    s_mov_b32 s61, s31
    s_mov_b32 s62, 5242880
    s_mov_b32 s63, 0x20000
    v_add_u32 v6, 86016, v40
    ds_read_b128 v[50:53], v40 offset:0
    ds_read_b128 v[54:57], v40 offset:21504
    ds_read_b128 v[58:61], v40 offset:43008
    ds_read_b128 v[62:65], v40 offset:64512
    ds_read_b128 v[66:69], v6
    v_add_u32 v6, 86016, v41
    ds_read_b128 v[70:73], v41 offset:0
    ds_read_b128 v[74:77], v41 offset:21504
    ds_read_b128 v[78:81], v41 offset:43008
    ds_read_b128 v[82:85], v41 offset:64512
    ds_read_b128 v[86:89], v6
    v_add_u32 v6, 86016, v42
    ds_read_b128 v[90:93], v42 offset:0
    ds_read_b128 v[94:97], v42 offset:21504
    ds_read_b128 v[98:101], v42 offset:43008
    ds_read_b128 v[102:105], v42 offset:64512
    ds_read_b128 v[106:109], v6
    s_waitcnt lgkmcnt(10)
    v_pk_add_f32 v[50:51], v[50:51], v[54:55]
    v_pk_add_f32 v[52:53], v[52:53], v[56:57]
    v_pk_add_f32 v[58:59], v[58:59], v[62:63]
    v_pk_add_f32 v[60:61], v[60:61], v[64:65]
    v_pk_add_f32 v[58:59], v[58:59], v[66:67]
    v_pk_add_f32 v[60:61], v[60:61], v[68:69]
    v_sub_f32 v7, 1.0, v30
    v_cvt_pk_bf16_f32 v7, v7, v7
    v_lshlrev_b32 v7, 16, v7
    v_cvt_pk_bf16_f32 v62, v58, v59
    v_and_b32 v63, s92, v62
    v_lshlrev_b32 v62, 16, v62
    v_mul_f32 v62, v7, v62
    v_mul_f32 v63, v7, v63
    v_cvt_pk_bf16_f32 v62, v62, v63
    v_lshlrev_b32 v58, 16, v62
    v_and_b32 v59, s92, v62
    v_cvt_pk_bf16_f32 v64, v60, v61
    v_and_b32 v65, s92, v64
    v_lshlrev_b32 v64, 16, v64
    v_mul_f32 v64, v7, v64
    v_mul_f32 v65, v7, v65
    v_cvt_pk_bf16_f32 v64, v64, v65
    v_lshlrev_b32 v60, 16, v64
    v_and_b32 v61, s92, v64
    v_pk_add_f32 v[50:51], v[50:51], v[10:11]
    v_pk_add_f32 v[52:53], v[52:53], v[12:13]
    v_fma_f32 v50, v30, v50, v58
    v_fma_f32 v51, v30, v51, v59
    v_fma_f32 v52, v30, v52, v60
    v_fma_f32 v53, v30, v53, v61
    buffer_store_dwordx4 v[50:53], v35, s[60:63], 0 offen sc1
    v_add_u32 v6, 86016, v43
    ds_read_b128 v[110:113], v43 offset:0
    ds_read_b128 v[114:117], v43 offset:21504
    ds_read_b128 v[118:121], v43 offset:43008
    ds_read_b128 v[122:125], v43 offset:64512
    ds_read_b128 v[126:129], v6
    s_waitcnt lgkmcnt(10)
    v_pk_add_f32 v[70:71], v[70:71], v[74:75]
    v_pk_add_f32 v[72:73], v[72:73], v[76:77]
    v_pk_add_f32 v[78:79], v[78:79], v[82:83]
    v_pk_add_f32 v[80:81], v[80:81], v[84:85]
    v_pk_add_f32 v[78:79], v[78:79], v[86:87]
    v_pk_add_f32 v[80:81], v[80:81], v[88:89]
    v_sub_f32 v7, 1.0, v31
    v_cvt_pk_bf16_f32 v7, v7, v7
    v_lshlrev_b32 v7, 16, v7
    v_cvt_pk_bf16_f32 v82, v78, v79
    v_and_b32 v83, s92, v82
    v_lshlrev_b32 v82, 16, v82
    v_mul_f32 v82, v7, v82
    v_mul_f32 v83, v7, v83
    v_cvt_pk_bf16_f32 v82, v82, v83
    v_lshlrev_b32 v78, 16, v82
    v_and_b32 v79, s92, v82
    v_cvt_pk_bf16_f32 v84, v80, v81
    v_and_b32 v85, s92, v84
    v_lshlrev_b32 v84, 16, v84
    v_mul_f32 v84, v7, v84
    v_mul_f32 v85, v7, v85
    v_cvt_pk_bf16_f32 v84, v84, v85
    v_lshlrev_b32 v80, 16, v84
    v_and_b32 v81, s92, v84
    v_pk_add_f32 v[70:71], v[70:71], v[14:15]
    v_pk_add_f32 v[72:73], v[72:73], v[16:17]
    v_fma_f32 v70, v31, v70, v78
    v_fma_f32 v71, v31, v71, v79
    v_fma_f32 v72, v31, v72, v80
    v_fma_f32 v73, v31, v73, v81
    buffer_store_dwordx4 v[70:73], v36, s[60:63], 0 offen sc1
    v_add_u32 v6, 86016, v44
    ds_read_b128 v[130:133], v44 offset:0
    ds_read_b128 v[134:137], v44 offset:21504
    ds_read_b128 v[138:141], v44 offset:43008
    ds_read_b128 v[142:145], v44 offset:64512
    ds_read_b128 v[146:149], v6
    s_waitcnt lgkmcnt(10)
    v_pk_add_f32 v[90:91], v[90:91], v[94:95]
    v_pk_add_f32 v[92:93], v[92:93], v[96:97]
    v_pk_add_f32 v[98:99], v[98:99], v[102:103]
    v_pk_add_f32 v[100:101], v[100:101], v[104:105]
    v_pk_add_f32 v[98:99], v[98:99], v[106:107]
    v_pk_add_f32 v[100:101], v[100:101], v[108:109]
    v_sub_f32 v7, 1.0, v32
    v_cvt_pk_bf16_f32 v7, v7, v7
    v_lshlrev_b32 v7, 16, v7
    v_cvt_pk_bf16_f32 v102, v98, v99
    v_and_b32 v103, s92, v102
    v_lshlrev_b32 v102, 16, v102
    v_mul_f32 v102, v7, v102
    v_mul_f32 v103, v7, v103
    v_cvt_pk_bf16_f32 v102, v102, v103
    v_lshlrev_b32 v98, 16, v102
    v_and_b32 v99, s92, v102
    v_cvt_pk_bf16_f32 v104, v100, v101
    v_and_b32 v105, s92, v104
    v_lshlrev_b32 v104, 16, v104
    v_mul_f32 v104, v7, v104
    v_mul_f32 v105, v7, v105
    v_cvt_pk_bf16_f32 v104, v104, v105
    v_lshlrev_b32 v100, 16, v104
    v_and_b32 v101, s92, v104
    v_pk_add_f32 v[90:91], v[90:91], v[18:19]
    v_pk_add_f32 v[92:93], v[92:93], v[20:21]
    v_fma_f32 v90, v32, v90, v98
    v_fma_f32 v91, v32, v91, v99
    v_fma_f32 v92, v32, v92, v100
    v_fma_f32 v93, v32, v93, v101
    buffer_store_dwordx4 v[90:93], v37, s[60:63], 0 offen sc1
    s_waitcnt lgkmcnt(5)
    v_pk_add_f32 v[110:111], v[110:111], v[114:115]
    v_pk_add_f32 v[112:113], v[112:113], v[116:117]
    v_pk_add_f32 v[118:119], v[118:119], v[122:123]
    v_pk_add_f32 v[120:121], v[120:121], v[124:125]
    v_pk_add_f32 v[118:119], v[118:119], v[126:127]
    v_pk_add_f32 v[120:121], v[120:121], v[128:129]
    v_sub_f32 v7, 1.0, v33
    v_cvt_pk_bf16_f32 v7, v7, v7
    v_lshlrev_b32 v7, 16, v7
    v_cvt_pk_bf16_f32 v122, v118, v119
    v_and_b32 v123, s92, v122
    v_lshlrev_b32 v122, 16, v122
    v_mul_f32 v122, v7, v122
    v_mul_f32 v123, v7, v123
    v_cvt_pk_bf16_f32 v122, v122, v123
    v_lshlrev_b32 v118, 16, v122
    v_and_b32 v119, s92, v122
    v_cvt_pk_bf16_f32 v124, v120, v121
    v_and_b32 v125, s92, v124
    v_lshlrev_b32 v124, 16, v124
    v_mul_f32 v124, v7, v124
    v_mul_f32 v125, v7, v125
    v_cvt_pk_bf16_f32 v124, v124, v125
    v_lshlrev_b32 v120, 16, v124
    v_and_b32 v121, s92, v124
    v_pk_add_f32 v[110:111], v[110:111], v[22:23]
    v_pk_add_f32 v[112:113], v[112:113], v[24:25]
    v_fma_f32 v110, v33, v110, v118
    v_fma_f32 v111, v33, v111, v119
    v_fma_f32 v112, v33, v112, v120
    v_fma_f32 v113, v33, v113, v121
    buffer_store_dwordx4 v[110:113], v38, s[60:63], 0 offen sc1
    s_waitcnt lgkmcnt(0)
    v_pk_add_f32 v[130:131], v[130:131], v[134:135]
    v_pk_add_f32 v[132:133], v[132:133], v[136:137]
    v_pk_add_f32 v[138:139], v[138:139], v[142:143]
    v_pk_add_f32 v[140:141], v[140:141], v[144:145]
    v_pk_add_f32 v[138:139], v[138:139], v[146:147]
    v_pk_add_f32 v[140:141], v[140:141], v[148:149]
    v_sub_f32 v7, 1.0, v34
    v_cvt_pk_bf16_f32 v7, v7, v7
    v_lshlrev_b32 v7, 16, v7
    v_cvt_pk_bf16_f32 v142, v138, v139
    v_and_b32 v143, s92, v142
    v_lshlrev_b32 v142, 16, v142
    v_mul_f32 v142, v7, v142
    v_mul_f32 v143, v7, v143
    v_cvt_pk_bf16_f32 v142, v142, v143
    v_lshlrev_b32 v138, 16, v142
    v_and_b32 v139, s92, v142
    v_cvt_pk_bf16_f32 v144, v140, v141
    v_and_b32 v145, s92, v144
    v_lshlrev_b32 v144, 16, v144
    v_mul_f32 v144, v7, v144
    v_mul_f32 v145, v7, v145
    v_cvt_pk_bf16_f32 v144, v144, v145
    v_lshlrev_b32 v140, 16, v144
    v_and_b32 v141, s92, v144
    v_pk_add_f32 v[130:131], v[130:131], v[26:27]
    v_pk_add_f32 v[132:133], v[132:133], v[28:29]
    v_fma_f32 v130, v34, v130, v138
    v_fma_f32 v131, v34, v131, v139
    v_fma_f32 v132, v34, v132, v140
    v_fma_f32 v133, v34, v133, v141
    buffer_store_dwordx4 v[130:133], v39, s[60:63], 0 offen sc1
L_exit:
    s_endpgm
.section .rodata,"a"
.p2align 6
.amdhsa_kernel gated_mix__ssm_conv_s5__dense_activation_relu__prompt_kernel
  .amdhsa_next_free_vgpr 512
  .amdhsa_next_free_sgpr 102
  .amdhsa_accum_offset 256
  .amdhsa_group_segment_fixed_size 0
  .amdhsa_kernarg_size 128
  .amdhsa_user_sgpr_count 2
  .amdhsa_user_sgpr_kernarg_segment_ptr 1
  .amdhsa_system_sgpr_workgroup_id_x 1
  .amdhsa_float_denorm_mode_32 3
.end_amdhsa_kernel
```
